```python
import torch

def _softmax(x, axis=-1):
    return torch.softmax(x, dim=axis)
def _gelu(x):
    return torch.nn.functional.gelu(x, approximate="tanh")
def _silu(x):
    return torch.nn.functional.silu(x)
def _sigmoid(x):
    return torch.sigmoid(x)
def _layernorm(x, axis=-1, eps=1e-5):
    m = x.mean(dim=axis, keepdim=True)
    v = x.var(dim=axis, keepdim=True, unbiased=False)
    return (x - m) / torch.sqrt(v + eps)
def _scatter_add(tgt, idx, src, axis=0):
    return tgt.clone().index_add_(axis, idx, src)
def _segment_sum(src, seg, n):
    out = torch.zeros((n,) + src.shape[1:], dtype=src.dtype)
    return out.index_add_(0, seg, src)
def _pad(x, pw):
    flat = tuple(v for pair in reversed(pw) for v in pair)
    return torch.nn.functional.pad(x, flat)

kernel_name = 'parallel_sum__sliding_block__mixer_channel_mlp__prompt'

def setup_inputs():

    _w = (lambda a: (lambda t: t.to(torch.bfloat16) if t.is_floating_point() else t)(torch.as_tensor(a)))
    def _A_setup():
        B, S, D = 1, 2048, 640
        return {
            "x": _w((lambda *s: torch.randn(*s, dtype=torch.bfloat16) * 0.05)(B, S, D)),
            "wqkv": _w((lambda *s: torch.randn(*s, dtype=torch.bfloat16) * 0.05)(D, 3 * D)),
            "wo": _w((lambda *s: torch.randn(*s, dtype=torch.bfloat16) * 0.05)(D, D)),
        }
    _A_in = _A_setup()

    def _B_setup():
        B, S, D, F = 1, 2048, 640, 1536
        return {
            "x": _w((lambda *s: torch.randn(*s, dtype=torch.bfloat16) * 0.05)(B, S, D)),
            "w1": _w((lambda *s: torch.randn(*s, dtype=torch.bfloat16) * 0.8)(D, F) * (D ** -0.5)),
            "b1": _w((lambda *s: torch.randn(*s, dtype=torch.bfloat16) * 0.8)(F)),
            "w2": _w((lambda *s: torch.randn(*s, dtype=torch.bfloat16) * 0.8)(F, D) * (F ** -0.5)),
            "b2": _w((lambda *s: torch.randn(*s, dtype=torch.bfloat16) * 0.4)(D)),
        }
    _B_in = _B_setup()

    return {
        "A_x": _A_in["x"],
        "A_wqkv": _A_in["wqkv"],
        "A_wo": _A_in["wo"],
        "B_x": _B_in["x"],
        "B_w1": _B_in["w1"],
        "B_b1": _B_in["b1"],
        "B_w2": _B_in["w2"],
        "B_b2": _B_in["b2"],
    }

def reference(A_x, A_wqkv, A_wo, B_x, B_w1, B_b1, B_w2, B_b2):
    def _A_ref(x, wqkv, wo):
        B, S, D = x.shape
        H = 32; Dh = D // H; W = 256
        qkv = (lambda x, *d: x.permute(*d))((x @ wqkv).reshape(B, S, 3, H, Dh), 2, 0, 3, 1, 4)
        q, k, v = qkv[0], qkv[1], qkv[2]
        scores = torch.einsum("bhqd,bhkd->bhqk", q, k) * (Dh ** -0.5)
        idx = torch.arange(S)
        mask = (idx[:, None] - idx[None, :] >= 0) & (idx[:, None] - idx[None, :] < W)
        scores = torch.where(mask[None, None], scores, -1e9)
        p = _softmax(scores, axis=-1)
        o = torch.einsum("bhqk,bhkd->bhqd", p, v)
        return (lambda x, *d: x.permute(*d))(o, 0, 2, 1, 3).reshape(B, S, D) @ wo

    def _B_ref(x, w1, b1, w2, b2):
        y = _layernorm(x, axis=-1)
        h = _gelu(torch.einsum("bsd,df->bsf", y, w1) + b1)
        return torch.einsum("bsf,fd->bsd", h, w2) + b2

    x = A_x
    xn = _layernorm(x, axis=-1)
    return x + _A_ref(xn, A_wqkv, A_wo) + _B_ref(xn, B_w1, B_b1, B_w2, B_b2)
```

```asm
; @launch grid=(256,1,1) block=(512,1,1) lds=163840
.amdgcn_target "amdgcn-amd-amdhsa--gfx950"
.text
.globl parallel_sum__sliding_block__mixer_channel_mlp__prompt_kernel
.p2align 8
.type parallel_sum__sliding_block__mixer_channel_mlp__prompt_kernel,@function
parallel_sum__sliding_block__mixer_channel_mlp__prompt_kernel:
  s_cmp_ge_u32 s2, 256
  s_cbranch_scc1 L_end
  s_load_dwordx2 s[4:5], s[0:1], 0
  s_load_dwordx2 s[8:9], s[0:1], 8
  s_load_dwordx2 s[12:13], s[0:1], 32
  s_load_dwordx2 s[16:17], s[0:1], 80
  s_load_dwordx16 s[60:75], s[0:1], 0
  s_load_dwordx4 s[76:79], s[0:1], 64
  s_load_dwordx2 s[80:81], s[0:1], 80
  v_lshrrev_b32 v1, 6, v0
  v_and_b32 v2, 63, v0
  v_readfirstlane_b32 s32, v1
  s_mov_b32 s6, 2621440
  s_mov_b32 s7, 0x20000
  s_mov_b32 s10, 2457600
  s_mov_b32 s11, 0x20000
  s_mov_b32 s14, 1966080
  s_mov_b32 s15, 0x20000
  s_mov_b32 s18, 720896
  s_mov_b32 s19, 0x20000
  s_and_b32 s37, s2, 7
  s_lshr_b32 s38, s2, 3
  s_lshr_b32 s33, s37, 2
  s_lshl_b32 s33, s33, 3
  s_and_b32 s39, s38, 7
  s_add_u32 s33, s33, s39
  s_and_b32 s34, s37, 3
  s_lshl_b32 s34, s34, 2
  s_lshr_b32 s39, s38, 3
  s_add_u32 s34, s34, s39
  s_min_u32 s41, s34, 14
  s_lshl_b32 s41, s41, 8
  s_mul_i32 s42, s34, 192
  s_and_b32 s35, s32, 3
  s_cmp_ge_u32 s32, 4
  s_cbranch_scc1 L_F
  s_getpc_b64 s[56:57]
L_pc:
  s_sub_u32 s56, s56, L_pc-parallel_sum__sliding_block__mixer_channel_mlp__prompt_kernel
  s_subb_u32 s57, s57, 0
  v_lshlrev_b32 v3, 7, v2
  s_lshl_b32 s37, s35, 13
  v_add_u32 v3, s37, v3
  v_add_u32 v8, 0x8000, v3
  v_min_u32 v8, L_codeend-parallel_sum__sliding_block__mixer_channel_mlp__prompt_kernel-4, v8
  v_mov_b32 v5, s57
  v_add_co_u32 v4, vcc, s56, v3
  s_nop 1
  v_addc_co_u32 v5, vcc, 0, v5, vcc
  global_load_dword v254, v[4:5], off
  v_mov_b32 v5, s57
  v_add_co_u32 v4, vcc, s56, v8
  s_nop 1
  v_addc_co_u32 v5, vcc, 0, v5, vcc
  global_load_dword v255, v[4:5], off
  v_and_b32 v3, 31, v2
  s_lshl_b32 s37, s35, 5
  v_add_u32 v3, s37, v3
  v_lshrrev_b32 v4, 5, v2
  v_bfe_u32 v5, v3, 1, 3
  v_xor_b32 v5, v5, v4
  v_lshlrev_b32 v3, 7, v3
  v_xor_b32 v6, 0, v5
  v_lshl_add_u32 v10, v6, 4, v3
  v_add_u32 v14, 65536, v10
  v_xor_b32 v6, 2, v5
  v_lshl_add_u32 v11, v6, 4, v3
  v_add_u32 v15, 65536, v11
  v_xor_b32 v6, 4, v5
  v_lshl_add_u32 v12, v6, 4, v3
  v_add_u32 v16, 65536, v12
  v_xor_b32 v6, 6, v5
  v_lshl_add_u32 v13, v6, 4, v3
  v_add_u32 v17, 65536, v13
  v_bfe_u32 v3, v2, 4, 1
  v_lshrrev_b32 v4, 5, v2
  v_bfe_u32 v5, v2, 2, 2
  v_and_b32 v6, 3, v2
  v_lshl_add_u32 v7, v4, 3, v5
  v_lshlrev_b32 v8, 8, v7
  v_add_u32 v8, 16384, v8
  v_lshrrev_b32 v9, 1, v6
  v_lshl_add_u32 v9, v3, 1, v9
  v_lshl_add_u32 v8, v9, 4, v8
  v_and_b32 v9, 1, v6
  v_lshl_add_u32 v8, v9, 3, v8
  v_xor_b32 v9, 0, v5
  v_lshl_add_u32 v18, v9, 6, v8
  v_add_u32 v22, 65536, v18
  v_xor_b32 v9, 1, v5
  v_lshl_add_u32 v19, v9, 6, v8
  v_add_u32 v23, 65536, v19
  v_xor_b32 v9, 2, v5
  v_lshl_add_u32 v20, v9, 6, v8
  v_add_u32 v24, 65536, v20
  v_xor_b32 v9, 3, v5
  v_lshl_add_u32 v21, v9, 6, v8
  v_add_u32 v25, 65536, v21
  v_and_b32 v70, 31, v2
  v_lshrrev_b32 v71, 5, v2
  s_and_b32 s37, s34, 3
  s_lshl_b32 s37, s37, 5
  s_lshl_b32 s38, s33, 7
  s_add_u32 s37, s37, s38
  v_add_u32 v70, s37, v70
  v_mul_u32_u24 v70, 1280, v70
  v_lshl_add_u32 v70, v71, 7, v70
  v_bfe_u32 v72, v2, 1, 3
  v_lshrrev_b32 v73, 4, v2
  v_lshl_add_u32 v72, v73, 6, v72
  s_and_b32 s37, s33, 7
  s_lshl_b32 s37, s37, 3
  v_add_u32 v72, s37, v72
  v_and_b32 v73, 1, v2
  v_lshlrev_b32 v73, 7, v73
  v_mul_u32_u24 v74, 3840, v72
  v_add_u32 v74, v74, v73
  v_add_u32 v74, s41, v74
  v_mul_u32_u24 v75, 3072, v72
  v_add_u32 v75, v75, v73
  v_add_u32 v75, s42, v75
  s_cmp_eq_u32 s35, 1
  s_cselect_b64 vcc, -1, 0
  s_nop 1
  v_cndmask_b32 v31, v70, v74, vcc
  s_cmp_eq_u32 s35, 2
  s_cselect_b64 vcc, -1, 0
  s_nop 1
  v_cndmask_b32 v31, v31, v75, vcc
  s_mov_b32 s44, 384
  s_mov_b32 s43, 512
  s_mov_b32 s40, 0x5
  s_cmp_eq_u32 s35, 3
  s_cselect_b32 s44, 640, s44
  s_cselect_b32 s40, 0xa, s40
  s_cmp_eq_u32 s35, 1
  s_cselect_b32 s44, 737280, s44
  s_cselect_b32 s43, 983040, s43
  s_cmp_eq_u32 s35, 2
  s_cselect_b32 s44, 0, s44
  s_cselect_b32 s43, 786432, s43
  s_cselect_b32 s40, 0xe, s40
  s_waitcnt lgkmcnt(0)
  s_cmp_eq_u32 s35, 1
  s_cselect_b32 s48, s8, s4
  s_cselect_b32 s49, s9, s5
  s_cselect_b32 s50, s10, s6
  s_cmp_eq_u32 s35, 2
  s_cselect_b32 s48, s12, s48
  s_cselect_b32 s49, s13, s49
  s_cselect_b32 s50, s14, s50
  s_mov_b32 s51, 0x20000
  v_mov_b32 v96, 0
  v_mov_b32 v97, 0
  v_mov_b32 v98, 0
  v_mov_b32 v99, 0
  v_mov_b32 v100, 0
  v_mov_b32 v101, 0
  v_mov_b32 v102, 0
  v_mov_b32 v103, 0
  v_mov_b32 v104, 0
  v_mov_b32 v105, 0
  v_mov_b32 v106, 0
  v_mov_b32 v107, 0
  v_mov_b32 v108, 0
  v_mov_b32 v109, 0
  v_mov_b32 v110, 0
  v_mov_b32 v111, 0
  v_mov_b32 v112, 0
  v_mov_b32 v113, 0
  v_mov_b32 v114, 0
  v_mov_b32 v115, 0
  v_mov_b32 v116, 0
  v_mov_b32 v117, 0
  v_mov_b32 v118, 0
  v_mov_b32 v119, 0
  v_mov_b32 v120, 0
  v_mov_b32 v121, 0
  v_mov_b32 v122, 0
  v_mov_b32 v123, 0
  v_mov_b32 v124, 0
  v_mov_b32 v125, 0
  v_mov_b32 v126, 0
  v_mov_b32 v127, 0
  v_mov_b32 v128, 0
  v_mov_b32 v129, 0
  v_mov_b32 v130, 0
  v_mov_b32 v131, 0
  v_mov_b32 v132, 0
  v_mov_b32 v133, 0
  v_mov_b32 v134, 0
  v_mov_b32 v135, 0
  v_mov_b32 v136, 0
  v_mov_b32 v137, 0
  v_mov_b32 v138, 0
  v_mov_b32 v139, 0
  v_mov_b32 v140, 0
  v_mov_b32 v141, 0
  v_mov_b32 v142, 0
  v_mov_b32 v143, 0
  v_mov_b32 v144, 0
  v_mov_b32 v145, 0
  v_mov_b32 v146, 0
  v_mov_b32 v147, 0
  v_mov_b32 v148, 0
  v_mov_b32 v149, 0
  v_mov_b32 v150, 0
  v_mov_b32 v151, 0
  v_mov_b32 v152, 0
  v_mov_b32 v153, 0
  v_mov_b32 v154, 0
  v_mov_b32 v155, 0
  v_mov_b32 v156, 0
  v_mov_b32 v157, 0
  v_mov_b32 v158, 0
  v_mov_b32 v159, 0
  s_barrier
  ds_read_b128 v[160:163], v10 offset:0
  ds_read_b64_tr_b16 v[164:165], v18 offset:0
  ds_read_b64_tr_b16 v[166:167], v18 offset:1024
  ds_read_b64_tr_b16 v[168:169], v19 offset:0
  ds_read_b64_tr_b16 v[170:171], v19 offset:1024
  ds_read_b64_tr_b16 v[172:173], v20 offset:0
  ds_read_b64_tr_b16 v[174:175], v20 offset:1024
  ds_read_b64_tr_b16 v[176:177], v21 offset:0
  ds_read_b64_tr_b16 v[178:179], v21 offset:1024
  ds_read_b128 v[180:183], v11 offset:0
  ds_read_b64_tr_b16 v[184:185], v18 offset:4096
  ds_read_b64_tr_b16 v[186:187], v18 offset:5120
  ds_read_b64_tr_b16 v[188:189], v19 offset:4096
  ds_read_b64_tr_b16 v[190:191], v19 offset:5120
  ds_read_b64_tr_b16 v[192:193], v20 offset:4096
  ds_read_b64_tr_b16 v[194:195], v20 offset:5120
  ds_read_b64_tr_b16 v[196:197], v21 offset:4096
  ds_read_b64_tr_b16 v[198:199], v21 offset:5120
  s_waitcnt lgkmcnt(9)
  v_mfma_f32_32x32x16_bf16 v[96:111], v[164:167], v[160:163], v[96:111]
  ds_read_b128 v[200:203], v12 offset:0
  ds_read_b64_tr_b16 v[204:205], v18 offset:8192
  ds_read_b64_tr_b16 v[206:207], v18 offset:9216
  v_mfma_f32_32x32x16_bf16 v[112:127], v[168:171], v[160:163], v[112:127]
  ds_read_b64_tr_b16 v[208:209], v19 offset:8192
  ds_read_b64_tr_b16 v[210:211], v19 offset:9216
  v_mfma_f32_32x32x16_bf16 v[128:143], v[172:175], v[160:163], v[128:143]
  ds_read_b64_tr_b16 v[212:213], v20 offset:8192
  ds_read_b64_tr_b16 v[214:215], v20 offset:9216
  v_mfma_f32_32x32x16_bf16 v[144:159], v[176:179], v[160:163], v[144:159]
  ds_read_b64_tr_b16 v[216:217], v21 offset:8192
  ds_read_b64_tr_b16 v[218:219], v21 offset:9216
  s_waitcnt lgkmcnt(9)
  v_mfma_f32_32x32x16_bf16 v[96:111], v[184:187], v[180:183], v[96:111]
  ds_read_b128 v[160:163], v13 offset:0
  ds_read_b64_tr_b16 v[164:165], v18 offset:12288
  ds_read_b64_tr_b16 v[166:167], v18 offset:13312
  v_mfma_f32_32x32x16_bf16 v[112:127], v[188:191], v[180:183], v[112:127]
  ds_read_b64_tr_b16 v[168:169], v19 offset:12288
  ds_read_b64_tr_b16 v[170:171], v19 offset:13312
  v_mfma_f32_32x32x16_bf16 v[128:143], v[192:195], v[180:183], v[128:143]
  ds_read_b64_tr_b16 v[172:173], v20 offset:12288
  ds_read_b64_tr_b16 v[174:175], v20 offset:13312
  v_mfma_f32_32x32x16_bf16 v[144:159], v[196:199], v[180:183], v[144:159]
  ds_read_b64_tr_b16 v[176:177], v21 offset:12288
  ds_read_b64_tr_b16 v[178:179], v21 offset:13312
  s_barrier
  s_waitcnt lgkmcnt(9)
  v_mfma_f32_32x32x16_bf16 v[96:111], v[204:207], v[200:203], v[96:111]
  ds_read_b128 v[180:183], v10 offset:32768
  ds_read_b64_tr_b16 v[184:185], v18 offset:32768
  ds_read_b64_tr_b16 v[186:187], v18 offset:33792
  v_mfma_f32_32x32x16_bf16 v[112:127], v[208:211], v[200:203], v[112:127]
  ds_read_b64_tr_b16 v[188:189], v19 offset:32768
  ds_read_b64_tr_b16 v[190:191], v19 offset:33792
  v_mfma_f32_32x32x16_bf16 v[128:143], v[212:215], v[200:203], v[128:143]
  ds_read_b64_tr_b16 v[192:193], v20 offset:32768
  ds_read_b64_tr_b16 v[194:195], v20 offset:33792
  v_mfma_f32_32x32x16_bf16 v[144:159], v[216:219], v[200:203], v[144:159]
  ds_read_b64_tr_b16 v[196:197], v21 offset:32768
  ds_read_b64_tr_b16 v[198:199], v21 offset:33792
  s_waitcnt lgkmcnt(9)
  v_mfma_f32_32x32x16_bf16 v[96:111], v[164:167], v[160:163], v[96:111]
  ds_read_b128 v[200:203], v11 offset:32768
  ds_read_b64_tr_b16 v[204:205], v18 offset:36864
  ds_read_b64_tr_b16 v[206:207], v18 offset:37888
  v_mfma_f32_32x32x16_bf16 v[112:127], v[168:171], v[160:163], v[112:127]
  ds_read_b64_tr_b16 v[208:209], v19 offset:36864
  ds_read_b64_tr_b16 v[210:211], v19 offset:37888
  v_mfma_f32_32x32x16_bf16 v[128:143], v[172:175], v[160:163], v[128:143]
  ds_read_b64_tr_b16 v[212:213], v20 offset:36864
  ds_read_b64_tr_b16 v[214:215], v20 offset:37888
  v_mfma_f32_32x32x16_bf16 v[144:159], v[176:179], v[160:163], v[144:159]
  ds_read_b64_tr_b16 v[216:217], v21 offset:36864
  ds_read_b64_tr_b16 v[218:219], v21 offset:37888
  s_waitcnt lgkmcnt(9)
  v_mfma_f32_32x32x16_bf16 v[96:111], v[184:187], v[180:183], v[96:111]
  ds_read_b128 v[160:163], v12 offset:32768
  ds_read_b64_tr_b16 v[164:165], v18 offset:40960
  ds_read_b64_tr_b16 v[166:167], v18 offset:41984
  v_mfma_f32_32x32x16_bf16 v[112:127], v[188:191], v[180:183], v[112:127]
  ds_read_b64_tr_b16 v[168:169], v19 offset:40960
  ds_read_b64_tr_b16 v[170:171], v19 offset:41984
  v_mfma_f32_32x32x16_bf16 v[128:143], v[192:195], v[180:183], v[128:143]
  ds_read_b64_tr_b16 v[172:173], v20 offset:40960
  ds_read_b64_tr_b16 v[174:175], v20 offset:41984
  v_mfma_f32_32x32x16_bf16 v[144:159], v[196:199], v[180:183], v[144:159]
  ds_read_b64_tr_b16 v[176:177], v21 offset:40960
  ds_read_b64_tr_b16 v[178:179], v21 offset:41984
  s_waitcnt lgkmcnt(9)
  v_mfma_f32_32x32x16_bf16 v[96:111], v[204:207], v[200:203], v[96:111]
  ds_read_b128 v[180:183], v13 offset:32768
  ds_read_b64_tr_b16 v[184:185], v18 offset:45056
  ds_read_b64_tr_b16 v[186:187], v18 offset:46080
  v_mfma_f32_32x32x16_bf16 v[112:127], v[208:211], v[200:203], v[112:127]
  ds_read_b64_tr_b16 v[188:189], v19 offset:45056
  ds_read_b64_tr_b16 v[190:191], v19 offset:46080
  v_mfma_f32_32x32x16_bf16 v[128:143], v[212:215], v[200:203], v[128:143]
  ds_read_b64_tr_b16 v[192:193], v20 offset:45056
  ds_read_b64_tr_b16 v[194:195], v20 offset:46080
  v_mfma_f32_32x32x16_bf16 v[144:159], v[216:219], v[200:203], v[144:159]
  ds_read_b64_tr_b16 v[196:197], v21 offset:45056
  ds_read_b64_tr_b16 v[198:199], v21 offset:46080
  s_barrier
  s_waitcnt lgkmcnt(9)
  v_mfma_f32_32x32x16_bf16 v[96:111], v[164:167], v[160:163], v[96:111]
  ds_read_b128 v[200:203], v14 offset:0
  ds_read_b64_tr_b16 v[204:205], v22 offset:0
  ds_read_b64_tr_b16 v[206:207], v22 offset:1024
  v_mfma_f32_32x32x16_bf16 v[112:127], v[168:171], v[160:163], v[112:127]
  ds_read_b64_tr_b16 v[208:209], v23 offset:0
  ds_read_b64_tr_b16 v[210:211], v23 offset:1024
  v_mfma_f32_32x32x16_bf16 v[128:143], v[172:175], v[160:163], v[128:143]
  ds_read_b64_tr_b16 v[212:213], v24 offset:0
  ds_read_b64_tr_b16 v[214:215], v24 offset:1024
  v_mfma_f32_32x32x16_bf16 v[144:159], v[176:179], v[160:163], v[144:159]
  ds_read_b64_tr_b16 v[216:217], v25 offset:0
  ds_read_b64_tr_b16 v[218:219], v25 offset:1024
  s_waitcnt lgkmcnt(9)
  v_mfma_f32_32x32x16_bf16 v[96:111], v[184:187], v[180:183], v[96:111]
  ds_read_b128 v[160:163], v15 offset:0
  ds_read_b64_tr_b16 v[164:165], v22 offset:4096
  ds_read_b64_tr_b16 v[166:167], v22 offset:5120
  v_mfma_f32_32x32x16_bf16 v[112:127], v[188:191], v[180:183], v[112:127]
  ds_read_b64_tr_b16 v[168:169], v23 offset:4096
  ds_read_b64_tr_b16 v[170:171], v23 offset:5120
  v_mfma_f32_32x32x16_bf16 v[128:143], v[192:195], v[180:183], v[128:143]
  ds_read_b64_tr_b16 v[172:173], v24 offset:4096
  ds_read_b64_tr_b16 v[174:175], v24 offset:5120
  v_mfma_f32_32x32x16_bf16 v[144:159], v[196:199], v[180:183], v[144:159]
  ds_read_b64_tr_b16 v[176:177], v25 offset:4096
  ds_read_b64_tr_b16 v[178:179], v25 offset:5120
  s_waitcnt lgkmcnt(9)
  v_mfma_f32_32x32x16_bf16 v[96:111], v[204:207], v[200:203], v[96:111]
  ds_read_b128 v[180:183], v16 offset:0
  ds_read_b64_tr_b16 v[184:185], v22 offset:8192
  ds_read_b64_tr_b16 v[186:187], v22 offset:9216
  v_mfma_f32_32x32x16_bf16 v[112:127], v[208:211], v[200:203], v[112:127]
  ds_read_b64_tr_b16 v[188:189], v23 offset:8192
  ds_read_b64_tr_b16 v[190:191], v23 offset:9216
  v_mfma_f32_32x32x16_bf16 v[128:143], v[212:215], v[200:203], v[128:143]
  ds_read_b64_tr_b16 v[192:193], v24 offset:8192
  ds_read_b64_tr_b16 v[194:195], v24 offset:9216
  v_mfma_f32_32x32x16_bf16 v[144:159], v[216:219], v[200:203], v[144:159]
  ds_read_b64_tr_b16 v[196:197], v25 offset:8192
  ds_read_b64_tr_b16 v[198:199], v25 offset:9216
  s_waitcnt lgkmcnt(9)
  v_mfma_f32_32x32x16_bf16 v[96:111], v[164:167], v[160:163], v[96:111]
  ds_read_b128 v[200:203], v17 offset:0
  ds_read_b64_tr_b16 v[204:205], v22 offset:12288
  ds_read_b64_tr_b16 v[206:207], v22 offset:13312
  v_mfma_f32_32x32x16_bf16 v[112:127], v[168:171], v[160:163], v[112:127]
  ds_read_b64_tr_b16 v[208:209], v23 offset:12288
  ds_read_b64_tr_b16 v[210:211], v23 offset:13312
  v_mfma_f32_32x32x16_bf16 v[128:143], v[172:175], v[160:163], v[128:143]
  ds_read_b64_tr_b16 v[212:213], v24 offset:12288
  ds_read_b64_tr_b16 v[214:215], v24 offset:13312
  v_mfma_f32_32x32x16_bf16 v[144:159], v[176:179], v[160:163], v[144:159]
  ds_read_b64_tr_b16 v[216:217], v25 offset:12288
  ds_read_b64_tr_b16 v[218:219], v25 offset:13312
  s_barrier
  s_waitcnt lgkmcnt(9)
  v_mfma_f32_32x32x16_bf16 v[96:111], v[184:187], v[180:183], v[96:111]
  ds_read_b128 v[160:163], v14 offset:32768
  ds_read_b64_tr_b16 v[164:165], v22 offset:32768
  ds_read_b64_tr_b16 v[166:167], v22 offset:33792
  v_mfma_f32_32x32x16_bf16 v[112:127], v[188:191], v[180:183], v[112:127]
  ds_read_b64_tr_b16 v[168:169], v23 offset:32768
  ds_read_b64_tr_b16 v[170:171], v23 offset:33792
  v_mfma_f32_32x32x16_bf16 v[128:143], v[192:195], v[180:183], v[128:143]
  ds_read_b64_tr_b16 v[172:173], v24 offset:32768
  ds_read_b64_tr_b16 v[174:175], v24 offset:33792
  v_mfma_f32_32x32x16_bf16 v[144:159], v[196:199], v[180:183], v[144:159]
  ds_read_b64_tr_b16 v[176:177], v25 offset:32768
  ds_read_b64_tr_b16 v[178:179], v25 offset:33792
  s_waitcnt lgkmcnt(9)
  v_mfma_f32_32x32x16_bf16 v[96:111], v[204:207], v[200:203], v[96:111]
  ds_read_b128 v[180:183], v15 offset:32768
  ds_read_b64_tr_b16 v[184:185], v22 offset:36864
  ds_read_b64_tr_b16 v[186:187], v22 offset:37888
  v_mfma_f32_32x32x16_bf16 v[112:127], v[208:211], v[200:203], v[112:127]
  ds_read_b64_tr_b16 v[188:189], v23 offset:36864
  ds_read_b64_tr_b16 v[190:191], v23 offset:37888
  v_mfma_f32_32x32x16_bf16 v[128:143], v[212:215], v[200:203], v[128:143]
  ds_read_b64_tr_b16 v[192:193], v24 offset:36864
  ds_read_b64_tr_b16 v[194:195], v24 offset:37888
  v_mfma_f32_32x32x16_bf16 v[144:159], v[216:219], v[200:203], v[144:159]
  ds_read_b64_tr_b16 v[196:197], v25 offset:36864
  ds_read_b64_tr_b16 v[198:199], v25 offset:37888
  s_waitcnt lgkmcnt(9)
  v_mfma_f32_32x32x16_bf16 v[96:111], v[164:167], v[160:163], v[96:111]
  ds_read_b128 v[200:203], v16 offset:32768
  ds_read_b64_tr_b16 v[204:205], v22 offset:40960
  ds_read_b64_tr_b16 v[206:207], v22 offset:41984
  v_mfma_f32_32x32x16_bf16 v[112:127], v[168:171], v[160:163], v[112:127]
  ds_read_b64_tr_b16 v[208:209], v23 offset:40960
  ds_read_b64_tr_b16 v[210:211], v23 offset:41984
  v_mfma_f32_32x32x16_bf16 v[128:143], v[172:175], v[160:163], v[128:143]
  ds_read_b64_tr_b16 v[212:213], v24 offset:40960
  ds_read_b64_tr_b16 v[214:215], v24 offset:41984
  v_mfma_f32_32x32x16_bf16 v[144:159], v[176:179], v[160:163], v[144:159]
  ds_read_b64_tr_b16 v[216:217], v25 offset:40960
  ds_read_b64_tr_b16 v[218:219], v25 offset:41984
  s_waitcnt lgkmcnt(9)
  v_mfma_f32_32x32x16_bf16 v[96:111], v[184:187], v[180:183], v[96:111]
  ds_read_b128 v[160:163], v17 offset:32768
  ds_read_b64_tr_b16 v[164:165], v22 offset:45056
  ds_read_b64_tr_b16 v[166:167], v22 offset:46080
  v_mfma_f32_32x32x16_bf16 v[112:127], v[188:191], v[180:183], v[112:127]
  ds_read_b64_tr_b16 v[168:169], v23 offset:45056
  ds_read_b64_tr_b16 v[170:171], v23 offset:46080
  v_mfma_f32_32x32x16_bf16 v[128:143], v[192:195], v[180:183], v[128:143]
  ds_read_b64_tr_b16 v[172:173], v24 offset:45056
  ds_read_b64_tr_b16 v[174:175], v24 offset:46080
  v_mfma_f32_32x32x16_bf16 v[144:159], v[196:199], v[180:183], v[144:159]
  ds_read_b64_tr_b16 v[176:177], v25 offset:45056
  ds_read_b64_tr_b16 v[178:179], v25 offset:46080
  s_barrier
  s_waitcnt lgkmcnt(9)
  v_mfma_f32_32x32x16_bf16 v[96:111], v[204:207], v[200:203], v[96:111]
  ds_read_b128 v[180:183], v10 offset:0
  ds_read_b64_tr_b16 v[184:185], v18 offset:0
  ds_read_b64_tr_b16 v[186:187], v18 offset:1024
  v_mfma_f32_32x32x16_bf16 v[112:127], v[208:211], v[200:203], v[112:127]
  ds_read_b64_tr_b16 v[188:189], v19 offset:0
  ds_read_b64_tr_b16 v[190:191], v19 offset:1024
  v_mfma_f32_32x32x16_bf16 v[128:143], v[212:215], v[200:203], v[128:143]
  ds_read_b64_tr_b16 v[192:193], v20 offset:0
  ds_read_b64_tr_b16 v[194:195], v20 offset:1024
  v_mfma_f32_32x32x16_bf16 v[144:159], v[216:219], v[200:203], v[144:159]
  ds_read_b64_tr_b16 v[196:197], v21 offset:0
  ds_read_b64_tr_b16 v[198:199], v21 offset:1024
  s_waitcnt lgkmcnt(9)
  v_mfma_f32_32x32x16_bf16 v[96:111], v[164:167], v[160:163], v[96:111]
  ds_read_b128 v[200:203], v11 offset:0
  ds_read_b64_tr_b16 v[204:205], v18 offset:4096
  ds_read_b64_tr_b16 v[206:207], v18 offset:5120
  v_mfma_f32_32x32x16_bf16 v[112:127], v[168:171], v[160:163], v[112:127]
  ds_read_b64_tr_b16 v[208:209], v19 offset:4096
  ds_read_b64_tr_b16 v[210:211], v19 offset:5120
  v_mfma_f32_32x32x16_bf16 v[128:143], v[172:175], v[160:163], v[128:143]
  ds_read_b64_tr_b16 v[212:213], v20 offset:4096
  ds_read_b64_tr_b16 v[214:215], v20 offset:5120
  v_mfma_f32_32x32x16_bf16 v[144:159], v[176:179], v[160:163], v[144:159]
  ds_read_b64_tr_b16 v[216:217], v21 offset:4096
  ds_read_b64_tr_b16 v[218:219], v21 offset:5120
  s_waitcnt lgkmcnt(9)
  v_mfma_f32_32x32x16_bf16 v[96:111], v[184:187], v[180:183], v[96:111]
  ds_read_b128 v[160:163], v12 offset:0
  ds_read_b64_tr_b16 v[164:165], v18 offset:8192
  ds_read_b64_tr_b16 v[166:167], v18 offset:9216
  v_mfma_f32_32x32x16_bf16 v[112:127], v[188:191], v[180:183], v[112:127]
  ds_read_b64_tr_b16 v[168:169], v19 offset:8192
  ds_read_b64_tr_b16 v[170:171], v19 offset:9216
  v_mfma_f32_32x32x16_bf16 v[128:143], v[192:195], v[180:183], v[128:143]
  ds_read_b64_tr_b16 v[172:173], v20 offset:8192
  ds_read_b64_tr_b16 v[174:175], v20 offset:9216
  v_mfma_f32_32x32x16_bf16 v[144:159], v[196:199], v[180:183], v[144:159]
  ds_read_b64_tr_b16 v[176:177], v21 offset:8192
  ds_read_b64_tr_b16 v[178:179], v21 offset:9216
  s_waitcnt lgkmcnt(9)
  v_mfma_f32_32x32x16_bf16 v[96:111], v[204:207], v[200:203], v[96:111]
  ds_read_b128 v[180:183], v13 offset:0
  ds_read_b64_tr_b16 v[184:185], v18 offset:12288
  ds_read_b64_tr_b16 v[186:187], v18 offset:13312
  v_mfma_f32_32x32x16_bf16 v[112:127], v[208:211], v[200:203], v[112:127]
  ds_read_b64_tr_b16 v[188:189], v19 offset:12288
  ds_read_b64_tr_b16 v[190:191], v19 offset:13312
  v_mfma_f32_32x32x16_bf16 v[128:143], v[212:215], v[200:203], v[128:143]
  ds_read_b64_tr_b16 v[192:193], v20 offset:12288
  ds_read_b64_tr_b16 v[194:195], v20 offset:13312
  v_mfma_f32_32x32x16_bf16 v[144:159], v[216:219], v[200:203], v[144:159]
  ds_read_b64_tr_b16 v[196:197], v21 offset:12288
  ds_read_b64_tr_b16 v[198:199], v21 offset:13312
  s_barrier
  s_waitcnt lgkmcnt(9)
  v_mfma_f32_32x32x16_bf16 v[96:111], v[164:167], v[160:163], v[96:111]
  ds_read_b128 v[200:203], v10 offset:32768
  ds_read_b64_tr_b16 v[204:205], v18 offset:32768
  ds_read_b64_tr_b16 v[206:207], v18 offset:33792
  v_mov_b32 v3, 156672
  ds_read_b32 v62, v3
  s_waitcnt lgkmcnt(0)
  v_mfma_f32_32x32x16_bf16 v[112:127], v[168:171], v[160:163], v[112:127]
  ds_read_b64_tr_b16 v[208:209], v19 offset:32768
  ds_read_b64_tr_b16 v[210:211], v19 offset:33792
  s_nop 0
  v_readfirstlane_b32 s82, v62
  v_and_b32 v3, 31, v2
  v_mfma_f32_32x32x16_bf16 v[128:143], v[172:175], v[160:163], v[128:143]
  ds_read_b64_tr_b16 v[212:213], v20 offset:32768
  ds_read_b64_tr_b16 v[214:215], v20 offset:33792
  s_lshl_b32 s37, s33, 7
  s_lshl_b32 s38, s35, 5
  s_add_u32 s37, s37, s38
  v_mfma_f32_32x32x16_bf16 v[144:159], v[176:179], v[160:163], v[144:159]
  ds_read_b64_tr_b16 v[216:217], v21 offset:32768
  ds_read_b64_tr_b16 v[218:219], v21 offset:33792
  v_add_u32 v3, s37, v3
  v_lshlrev_b32 v91, 3, v3
  v_lshlrev_b32 v90, 4, v3
  s_waitcnt lgkmcnt(10)
  v_mfma_f32_32x32x16_bf16 v[96:111], v[184:187], v[180:183], v[96:111]
  ds_read_b128 v[160:163], v11 offset:32768
  ds_read_b64_tr_b16 v[164:165], v18 offset:36864
  ds_read_b64_tr_b16 v[166:167], v18 offset:37888
  v_mfma_f32_32x32x16_bf16 v[112:127], v[188:191], v[180:183], v[112:127]
  ds_read_b64_tr_b16 v[168:169], v19 offset:36864
  ds_read_b64_tr_b16 v[170:171], v19 offset:37888
  v_mfma_f32_32x32x16_bf16 v[128:143], v[192:195], v[180:183], v[128:143]
  ds_read_b64_tr_b16 v[172:173], v20 offset:36864
  ds_read_b64_tr_b16 v[174:175], v20 offset:37888
  v_mfma_f32_32x32x16_bf16 v[144:159], v[196:199], v[180:183], v[144:159]
  ds_read_b64_tr_b16 v[176:177], v21 offset:36864
  ds_read_b64_tr_b16 v[178:179], v21 offset:37888
  s_waitcnt lgkmcnt(9)
  v_mfma_f32_32x32x16_bf16 v[96:111], v[204:207], v[200:203], v[96:111]
  ds_read_b128 v[180:183], v12 offset:32768
  ds_read_b64_tr_b16 v[184:185], v18 offset:40960
  ds_read_b64_tr_b16 v[186:187], v18 offset:41984
  v_mfma_f32_32x32x16_bf16 v[112:127], v[208:211], v[200:203], v[112:127]
  ds_read_b64_tr_b16 v[188:189], v19 offset:40960
  ds_read_b64_tr_b16 v[190:191], v19 offset:41984
  v_mfma_f32_32x32x16_bf16 v[128:143], v[212:215], v[200:203], v[128:143]
  ds_read_b64_tr_b16 v[192:193], v20 offset:40960
  ds_read_b64_tr_b16 v[194:195], v20 offset:41984
  v_mfma_f32_32x32x16_bf16 v[144:159], v[216:219], v[200:203], v[144:159]
  ds_read_b64_tr_b16 v[196:197], v21 offset:40960
  ds_read_b64_tr_b16 v[198:199], v21 offset:41984
  s_waitcnt lgkmcnt(9)
  v_mfma_f32_32x32x16_bf16 v[96:111], v[164:167], v[160:163], v[96:111]
  ds_read_b128 v[200:203], v13 offset:32768
  ds_read_b64_tr_b16 v[204:205], v18 offset:45056
  ds_read_b64_tr_b16 v[206:207], v18 offset:46080
  v_mfma_f32_32x32x16_bf16 v[112:127], v[168:171], v[160:163], v[112:127]
  ds_read_b64_tr_b16 v[208:209], v19 offset:45056
  ds_read_b64_tr_b16 v[210:211], v19 offset:46080
  v_mfma_f32_32x32x16_bf16 v[128:143], v[172:175], v[160:163], v[128:143]
  ds_read_b64_tr_b16 v[212:213], v20 offset:45056
  ds_read_b64_tr_b16 v[214:215], v20 offset:46080
  v_mfma_f32_32x32x16_bf16 v[144:159], v[176:179], v[160:163], v[144:159]
  ds_read_b64_tr_b16 v[216:217], v21 offset:45056
  ds_read_b64_tr_b16 v[218:219], v21 offset:46080
  s_barrier
  s_waitcnt lgkmcnt(9)
  v_mfma_f32_32x32x16_bf16 v[96:111], v[184:187], v[180:183], v[96:111]
  ds_read_b128 v[160:163], v14 offset:0
  ds_read_b64_tr_b16 v[164:165], v22 offset:0
  ds_read_b64_tr_b16 v[166:167], v22 offset:1024
  v_mfma_f32_32x32x16_bf16 v[112:127], v[188:191], v[180:183], v[112:127]
  ds_read_b64_tr_b16 v[168:169], v23 offset:0
  ds_read_b64_tr_b16 v[170:171], v23 offset:1024
  v_mfma_f32_32x32x16_bf16 v[128:143], v[192:195], v[180:183], v[128:143]
  ds_read_b64_tr_b16 v[172:173], v24 offset:0
  ds_read_b64_tr_b16 v[174:175], v24 offset:1024
  v_mfma_f32_32x32x16_bf16 v[144:159], v[196:199], v[180:183], v[144:159]
  ds_read_b64_tr_b16 v[176:177], v25 offset:0
  ds_read_b64_tr_b16 v[178:179], v25 offset:1024
  s_waitcnt lgkmcnt(9)
  v_mfma_f32_32x32x16_bf16 v[96:111], v[204:207], v[200:203], v[96:111]
  ds_read_b128 v[180:183], v15 offset:0
  ds_read_b64_tr_b16 v[184:185], v22 offset:4096
  ds_read_b64_tr_b16 v[186:187], v22 offset:5120
  v_mfma_f32_32x32x16_bf16 v[112:127], v[208:211], v[200:203], v[112:127]
  ds_read_b64_tr_b16 v[188:189], v23 offset:4096
  ds_read_b64_tr_b16 v[190:191], v23 offset:5120
  v_mfma_f32_32x32x16_bf16 v[128:143], v[212:215], v[200:203], v[128:143]
  ds_read_b64_tr_b16 v[192:193], v24 offset:4096
  ds_read_b64_tr_b16 v[194:195], v24 offset:5120
  v_mfma_f32_32x32x16_bf16 v[144:159], v[216:219], v[200:203], v[144:159]
  ds_read_b64_tr_b16 v[196:197], v25 offset:4096
  ds_read_b64_tr_b16 v[198:199], v25 offset:5120
  s_waitcnt lgkmcnt(9)
  v_mfma_f32_32x32x16_bf16 v[96:111], v[164:167], v[160:163], v[96:111]
  ds_read_b128 v[200:203], v16 offset:0
  ds_read_b64_tr_b16 v[204:205], v22 offset:8192
  ds_read_b64_tr_b16 v[206:207], v22 offset:9216
  v_mfma_f32_32x32x16_bf16 v[112:127], v[168:171], v[160:163], v[112:127]
  ds_read_b64_tr_b16 v[208:209], v23 offset:8192
  ds_read_b64_tr_b16 v[210:211], v23 offset:9216
  v_mfma_f32_32x32x16_bf16 v[128:143], v[172:175], v[160:163], v[128:143]
  ds_read_b64_tr_b16 v[212:213], v24 offset:8192
  ds_read_b64_tr_b16 v[214:215], v24 offset:9216
  v_mfma_f32_32x32x16_bf16 v[144:159], v[176:179], v[160:163], v[144:159]
  ds_read_b64_tr_b16 v[216:217], v25 offset:8192
  ds_read_b64_tr_b16 v[218:219], v25 offset:9216
  s_waitcnt lgkmcnt(9)
  v_mfma_f32_32x32x16_bf16 v[96:111], v[184:187], v[180:183], v[96:111]
  ds_read_b128 v[160:163], v17 offset:0
  ds_read_b64_tr_b16 v[164:165], v22 offset:12288
  ds_read_b64_tr_b16 v[166:167], v22 offset:13312
  v_mfma_f32_32x32x16_bf16 v[112:127], v[188:191], v[180:183], v[112:127]
  ds_read_b64_tr_b16 v[168:169], v23 offset:12288
  ds_read_b64_tr_b16 v[170:171], v23 offset:13312
  v_mfma_f32_32x32x16_bf16 v[128:143], v[192:195], v[180:183], v[128:143]
  ds_read_b64_tr_b16 v[172:173], v24 offset:12288
  ds_read_b64_tr_b16 v[174:175], v24 offset:13312
  v_mfma_f32_32x32x16_bf16 v[144:159], v[196:199], v[180:183], v[144:159]
  ds_read_b64_tr_b16 v[176:177], v25 offset:12288
  ds_read_b64_tr_b16 v[178:179], v25 offset:13312
  s_barrier
  s_waitcnt lgkmcnt(9)
  v_mfma_f32_32x32x16_bf16 v[96:111], v[204:207], v[200:203], v[96:111]
  ds_read_b128 v[180:183], v14 offset:32768
  ds_read_b64_tr_b16 v[184:185], v22 offset:32768
  ds_read_b64_tr_b16 v[186:187], v22 offset:33792
  buffer_load_dwordx4 v[92:95], v90, s[16:19], 0 offen sc1
  v_mfma_f32_32x32x16_bf16 v[112:127], v[208:211], v[200:203], v[112:127]
  ds_read_b64_tr_b16 v[188:189], v23 offset:32768
  ds_read_b64_tr_b16 v[190:191], v23 offset:33792
  v_mfma_f32_32x32x16_bf16 v[128:143], v[212:215], v[200:203], v[128:143]
  ds_read_b64_tr_b16 v[192:193], v24 offset:32768
  ds_read_b64_tr_b16 v[194:195], v24 offset:33792
  v_mfma_f32_32x32x16_bf16 v[144:159], v[216:219], v[200:203], v[144:159]
  ds_read_b64_tr_b16 v[196:197], v25 offset:32768
  ds_read_b64_tr_b16 v[198:199], v25 offset:33792
  s_waitcnt lgkmcnt(9)
  v_mfma_f32_32x32x16_bf16 v[96:111], v[164:167], v[160:163], v[96:111]
  ds_read_b128 v[200:203], v15 offset:32768
  ds_read_b64_tr_b16 v[204:205], v22 offset:36864
  ds_read_b64_tr_b16 v[206:207], v22 offset:37888
  v_mfma_f32_32x32x16_bf16 v[112:127], v[168:171], v[160:163], v[112:127]
  ds_read_b64_tr_b16 v[208:209], v23 offset:36864
  ds_read_b64_tr_b16 v[210:211], v23 offset:37888
  v_mfma_f32_32x32x16_bf16 v[128:143], v[172:175], v[160:163], v[128:143]
  ds_read_b64_tr_b16 v[212:213], v24 offset:36864
  ds_read_b64_tr_b16 v[214:215], v24 offset:37888
  v_mfma_f32_32x32x16_bf16 v[144:159], v[176:179], v[160:163], v[144:159]
  ds_read_b64_tr_b16 v[216:217], v25 offset:36864
  ds_read_b64_tr_b16 v[218:219], v25 offset:37888
  s_waitcnt lgkmcnt(9)
  v_mfma_f32_32x32x16_bf16 v[96:111], v[184:187], v[180:183], v[96:111]
  ds_read_b128 v[160:163], v16 offset:32768
  ds_read_b64_tr_b16 v[164:165], v22 offset:40960
  ds_read_b64_tr_b16 v[166:167], v22 offset:41984
  v_mfma_f32_32x32x16_bf16 v[112:127], v[188:191], v[180:183], v[112:127]
  ds_read_b64_tr_b16 v[168:169], v23 offset:40960
  ds_read_b64_tr_b16 v[170:171], v23 offset:41984
  v_mfma_f32_32x32x16_bf16 v[128:143], v[192:195], v[180:183], v[128:143]
  ds_read_b64_tr_b16 v[172:173], v24 offset:40960
  ds_read_b64_tr_b16 v[174:175], v24 offset:41984
  v_mfma_f32_32x32x16_bf16 v[144:159], v[196:199], v[180:183], v[144:159]
  ds_read_b64_tr_b16 v[176:177], v25 offset:40960
  ds_read_b64_tr_b16 v[178:179], v25 offset:41984
  s_waitcnt lgkmcnt(9)
  v_mfma_f32_32x32x16_bf16 v[96:111], v[204:207], v[200:203], v[96:111]
  ds_read_b128 v[180:183], v17 offset:32768
  ds_read_b64_tr_b16 v[184:185], v22 offset:45056
  ds_read_b64_tr_b16 v[186:187], v22 offset:46080
  v_mfma_f32_32x32x16_bf16 v[112:127], v[208:211], v[200:203], v[112:127]
  ds_read_b64_tr_b16 v[188:189], v23 offset:45056
  ds_read_b64_tr_b16 v[190:191], v23 offset:46080
  v_mfma_f32_32x32x16_bf16 v[128:143], v[212:215], v[200:203], v[128:143]
  ds_read_b64_tr_b16 v[192:193], v24 offset:45056
  ds_read_b64_tr_b16 v[194:195], v24 offset:46080
  v_mfma_f32_32x32x16_bf16 v[144:159], v[216:219], v[200:203], v[144:159]
  ds_read_b64_tr_b16 v[196:197], v25 offset:45056
  ds_read_b64_tr_b16 v[198:199], v25 offset:46080
  s_barrier
  s_waitcnt lgkmcnt(9)
  v_mfma_f32_32x32x16_bf16 v[96:111], v[164:167], v[160:163], v[96:111]
  ds_read_b128 v[200:203], v10 offset:0
  ds_read_b64_tr_b16 v[204:205], v18 offset:0
  ds_read_b64_tr_b16 v[206:207], v18 offset:1024
  v_mfma_f32_32x32x16_bf16 v[112:127], v[168:171], v[160:163], v[112:127]
  ds_read_b64_tr_b16 v[208:209], v19 offset:0
  ds_read_b64_tr_b16 v[210:211], v19 offset:1024
  v_mfma_f32_32x32x16_bf16 v[128:143], v[172:175], v[160:163], v[128:143]
  ds_read_b64_tr_b16 v[212:213], v20 offset:0
  ds_read_b64_tr_b16 v[214:215], v20 offset:1024
  v_mfma_f32_32x32x16_bf16 v[144:159], v[176:179], v[160:163], v[144:159]
  ds_read_b64_tr_b16 v[216:217], v21 offset:0
  ds_read_b64_tr_b16 v[218:219], v21 offset:1024
  s_waitcnt lgkmcnt(9)
  v_mfma_f32_32x32x16_bf16 v[96:111], v[184:187], v[180:183], v[96:111]
  ds_read_b128 v[160:163], v11 offset:0
  ds_read_b64_tr_b16 v[164:165], v18 offset:4096
  ds_read_b64_tr_b16 v[166:167], v18 offset:5120
  v_mfma_f32_32x32x16_bf16 v[112:127], v[188:191], v[180:183], v[112:127]
  ds_read_b64_tr_b16 v[168:169], v19 offset:4096
  ds_read_b64_tr_b16 v[170:171], v19 offset:5120
  v_mfma_f32_32x32x16_bf16 v[128:143], v[192:195], v[180:183], v[128:143]
  ds_read_b64_tr_b16 v[172:173], v20 offset:4096
  ds_read_b64_tr_b16 v[174:175], v20 offset:5120
  v_mfma_f32_32x32x16_bf16 v[144:159], v[196:199], v[180:183], v[144:159]
  ds_read_b64_tr_b16 v[176:177], v21 offset:4096
  ds_read_b64_tr_b16 v[178:179], v21 offset:5120
  s_waitcnt lgkmcnt(9)
  v_mfma_f32_32x32x16_bf16 v[96:111], v[204:207], v[200:203], v[96:111]
  ds_read_b128 v[180:183], v12 offset:0
  ds_read_b64_tr_b16 v[184:185], v18 offset:8192
  ds_read_b64_tr_b16 v[186:187], v18 offset:9216
  v_mfma_f32_32x32x16_bf16 v[112:127], v[208:211], v[200:203], v[112:127]
  ds_read_b64_tr_b16 v[188:189], v19 offset:8192
  ds_read_b64_tr_b16 v[190:191], v19 offset:9216
  v_mfma_f32_32x32x16_bf16 v[128:143], v[212:215], v[200:203], v[128:143]
  ds_read_b64_tr_b16 v[192:193], v20 offset:8192
  ds_read_b64_tr_b16 v[194:195], v20 offset:9216
  v_mfma_f32_32x32x16_bf16 v[144:159], v[216:219], v[200:203], v[144:159]
  ds_read_b64_tr_b16 v[196:197], v21 offset:8192
  ds_read_b64_tr_b16 v[198:199], v21 offset:9216
  s_waitcnt lgkmcnt(9)
  v_mfma_f32_32x32x16_bf16 v[96:111], v[164:167], v[160:163], v[96:111]
  ds_read_b128 v[200:203], v13 offset:0
  ds_read_b64_tr_b16 v[204:205], v18 offset:12288
  ds_read_b64_tr_b16 v[206:207], v18 offset:13312
  v_mfma_f32_32x32x16_bf16 v[112:127], v[168:171], v[160:163], v[112:127]
  ds_read_b64_tr_b16 v[208:209], v19 offset:12288
  ds_read_b64_tr_b16 v[210:211], v19 offset:13312
  v_mfma_f32_32x32x16_bf16 v[128:143], v[172:175], v[160:163], v[128:143]
  ds_read_b64_tr_b16 v[212:213], v20 offset:12288
  ds_read_b64_tr_b16 v[214:215], v20 offset:13312
  v_mfma_f32_32x32x16_bf16 v[144:159], v[176:179], v[160:163], v[144:159]
  ds_read_b64_tr_b16 v[216:217], v21 offset:12288
  ds_read_b64_tr_b16 v[218:219], v21 offset:13312
  s_barrier
  s_waitcnt lgkmcnt(9)
  v_mfma_f32_32x32x16_bf16 v[96:111], v[184:187], v[180:183], v[96:111]
  ds_read_b128 v[160:163], v10 offset:32768
  ds_read_b64_tr_b16 v[164:165], v18 offset:32768
  ds_read_b64_tr_b16 v[166:167], v18 offset:33792
  v_mfma_f32_32x32x16_bf16 v[112:127], v[188:191], v[180:183], v[112:127]
  ds_read_b64_tr_b16 v[168:169], v19 offset:32768
  ds_read_b64_tr_b16 v[170:171], v19 offset:33792
  v_mfma_f32_32x32x16_bf16 v[128:143], v[192:195], v[180:183], v[128:143]
  ds_read_b64_tr_b16 v[172:173], v20 offset:32768
  ds_read_b64_tr_b16 v[174:175], v20 offset:33792
  v_mfma_f32_32x32x16_bf16 v[144:159], v[196:199], v[180:183], v[144:159]
  ds_read_b64_tr_b16 v[176:177], v21 offset:32768
  ds_read_b64_tr_b16 v[178:179], v21 offset:33792
  s_waitcnt lgkmcnt(9)
  v_mfma_f32_32x32x16_bf16 v[96:111], v[204:207], v[200:203], v[96:111]
  ds_read_b128 v[180:183], v11 offset:32768
  ds_read_b64_tr_b16 v[184:185], v18 offset:36864
  ds_read_b64_tr_b16 v[186:187], v18 offset:37888
  v_mfma_f32_32x32x16_bf16 v[112:127], v[208:211], v[200:203], v[112:127]
  ds_read_b64_tr_b16 v[188:189], v19 offset:36864
  ds_read_b64_tr_b16 v[190:191], v19 offset:37888
  v_mfma_f32_32x32x16_bf16 v[128:143], v[212:215], v[200:203], v[128:143]
  ds_read_b64_tr_b16 v[192:193], v20 offset:36864
  ds_read_b64_tr_b16 v[194:195], v20 offset:37888
  v_mfma_f32_32x32x16_bf16 v[144:159], v[216:219], v[200:203], v[144:159]
  ds_read_b64_tr_b16 v[196:197], v21 offset:36864
  ds_read_b64_tr_b16 v[198:199], v21 offset:37888
  s_waitcnt lgkmcnt(9)
  v_mfma_f32_32x32x16_bf16 v[96:111], v[164:167], v[160:163], v[96:111]
  ds_read_b128 v[200:203], v12 offset:32768
  ds_read_b64_tr_b16 v[204:205], v18 offset:40960
  ds_read_b64_tr_b16 v[206:207], v18 offset:41984
  v_mfma_f32_32x32x16_bf16 v[112:127], v[168:171], v[160:163], v[112:127]
  ds_read_b64_tr_b16 v[208:209], v19 offset:40960
  ds_read_b64_tr_b16 v[210:211], v19 offset:41984
  v_mfma_f32_32x32x16_bf16 v[128:143], v[172:175], v[160:163], v[128:143]
  ds_read_b64_tr_b16 v[212:213], v20 offset:40960
  ds_read_b64_tr_b16 v[214:215], v20 offset:41984
  v_mfma_f32_32x32x16_bf16 v[144:159], v[176:179], v[160:163], v[144:159]
  ds_read_b64_tr_b16 v[216:217], v21 offset:40960
  ds_read_b64_tr_b16 v[218:219], v21 offset:41984
  s_waitcnt lgkmcnt(9)
  v_mfma_f32_32x32x16_bf16 v[96:111], v[184:187], v[180:183], v[96:111]
  ds_read_b128 v[160:163], v13 offset:32768
  ds_read_b64_tr_b16 v[164:165], v18 offset:45056
  ds_read_b64_tr_b16 v[166:167], v18 offset:46080
  v_mfma_f32_32x32x16_bf16 v[112:127], v[188:191], v[180:183], v[112:127]
  ds_read_b64_tr_b16 v[168:169], v19 offset:45056
  ds_read_b64_tr_b16 v[170:171], v19 offset:46080
  v_mfma_f32_32x32x16_bf16 v[128:143], v[192:195], v[180:183], v[128:143]
  ds_read_b64_tr_b16 v[172:173], v20 offset:45056
  ds_read_b64_tr_b16 v[174:175], v20 offset:46080
  v_mfma_f32_32x32x16_bf16 v[144:159], v[196:199], v[180:183], v[144:159]
  ds_read_b64_tr_b16 v[176:177], v21 offset:45056
  ds_read_b64_tr_b16 v[178:179], v21 offset:46080
  s_waitcnt lgkmcnt(9)
  v_mfma_f32_32x32x16_bf16 v[96:111], v[204:207], v[200:203], v[96:111]
  v_mfma_f32_32x32x16_bf16 v[112:127], v[208:211], v[200:203], v[112:127]
  v_mfma_f32_32x32x16_bf16 v[128:143], v[212:215], v[200:203], v[128:143]
  v_mfma_f32_32x32x16_bf16 v[144:159], v[216:219], v[200:203], v[144:159]
  s_waitcnt lgkmcnt(0)
  v_mfma_f32_32x32x16_bf16 v[96:111], v[164:167], v[160:163], v[96:111]
  v_mfma_f32_32x32x16_bf16 v[112:127], v[168:171], v[160:163], v[112:127]
  v_mfma_f32_32x32x16_bf16 v[128:143], v[172:175], v[160:163], v[128:143]
  v_mfma_f32_32x32x16_bf16 v[144:159], v[176:179], v[160:163], v[144:159]
  v_mov_b32 v3, 156724
  v_mov_b32 v4, 1
  s_mov_b64 exec, 1
  ds_add_u32 v3, v4
  s_mov_b64 exec, -1
  s_add_u32 s20, s80, 3538944
  s_addc_u32 s21, s81, 0
  s_mov_b32 s22, 7864320
  s_mov_b32 s23, 0x20000
  s_cmp_eq_u32 s34, 15
  s_cselect_b32 s22, 0, s22
  s_mul_i32 s45, s34, 205
  s_lshr_b32 s45, s45, 10
  s_mul_i32 s46, s45, 5
  s_sub_u32 s46, s34, s46
  v_lshrrev_b32 v4, 5, v2
  v_lshlrev_b32 v26, 4, v4
  v_add_u32 v26, 155648, v26
  v_lshlrev_b32 v4, 14, v4
  v_add_u32 v91, v91, v4
  v_and_b32 v8, 31, v2
  s_lshl_b32 s37, s35, 5
  v_add_u32 v8, s37, v8
  v_lshlrev_b32 v8, 3, v8
  v_add_u32 v8, 157312, v8
  s_waitcnt vmcnt(0)
  v_cmp_ne_u32 vcc, s82, v95
  s_cbranch_vccz spd_7
  s_mov_b32 s37, 0
sp_6:
  buffer_load_dwordx4 v[92:95], v90, s[16:19], 0 offen sc1
  s_waitcnt vmcnt(0)
  v_cmp_ne_u32 vcc, s82, v95
  s_cbranch_vccz spd_7
  s_add_u32 s37, s37, 1
  s_cmp_lt_u32 s37, 20000
  s_cbranch_scc0 spd_7
  s_sleep 2
  s_branch sp_6
spd_7:
  v_mul_f32 v6, v92, v94
  v_sub_f32 v6, 0, v6
  v_mov_b32 v7, v94
  ds_write_b64 v8, v[6:7]
  v_mul_f32 v94, 0x3ea52b5c, v93
  s_cmp_eq_u32 s45, 0
  s_cselect_b64 vcc, -1, 0
  s_nop 1
  v_cndmask_b32 v93, v93, v94, vcc
  v_sub_f32 v92, 0, v92
  s_mul_i32 s45, s45, 2621440
  s_lshl_b32 s46, s46, 19
  s_add_u32 s45, s45, s46
  s_waitcnt lgkmcnt(0)
  v_mov_b32 v3, 156740
  v_mov_b32 v4, 1
  s_mov_b64 exec, 1
  ds_add_u32 v3, v4
  s_mov_b64 exec, -1
  v_mov_b32 v3, 156736
  s_mov_b32 s37, 0
lw_8:
  ds_read_b32 v4, v3
  s_waitcnt lgkmcnt(0)
  v_cmp_gt_u32 vcc, 4, v4
  s_cbranch_vccz lwd_9
  s_add_u32 s37, s37, 1
  s_cmp_lt_u32 s37, 640000
  s_cbranch_scc0 lwd_9
  s_sleep 1
  s_branch lw_8
lwd_9:
  ds_read_b128 v[160:163], v26 offset:0
  ds_read_b128 v[164:167], v26 offset:32
  ds_read_b128 v[168:171], v26 offset:64
  ds_read_b128 v[172:175], v26 offset:96
  ds_read_b128 v[176:179], v26 offset:128
  ds_read_b128 v[180:183], v26 offset:160
  ds_read_b128 v[184:187], v26 offset:192
  ds_read_b128 v[188:191], v26 offset:224
  ds_read_b128 v[192:195], v26 offset:256
  ds_read_b128 v[196:199], v26 offset:288
  ds_read_b128 v[200:203], v26 offset:320
  ds_read_b128 v[204:207], v26 offset:352
  ds_read_b128 v[208:211], v26 offset:384
  ds_read_b128 v[212:215], v26 offset:416
  ds_read_b128 v[216:219], v26 offset:448
  ds_read_b128 v[220:223], v26 offset:480
  s_waitcnt lgkmcnt(12)
  v_fma_f32 v96, v92, v160, v96
  v_fma_f32 v97, v92, v161, v97
  v_fma_f32 v98, v92, v162, v98
  v_fma_f32 v99, v92, v163, v99
  v_mul_f32 v96, v96, v93
  v_mul_f32 v97, v97, v93
  v_mul_f32 v98, v98, v93
  v_mul_f32 v99, v99, v93
  v_cvt_pk_bf16_f32 v40, v96, v97
  v_cvt_pk_bf16_f32 v41, v98, v99
  s_add_u32 s46, s45, 0
  buffer_store_dwordx2 v[40:41], v91, s[20:23], s46 offen sc1
  v_fma_f32 v100, v92, v164, v100
  v_fma_f32 v101, v92, v165, v101
  v_fma_f32 v102, v92, v166, v102
  v_fma_f32 v103, v92, v167, v103
  v_mul_f32 v100, v100, v93
  v_mul_f32 v101, v101, v93
  v_mul_f32 v102, v102, v93
  v_mul_f32 v103, v103, v93
  v_cvt_pk_bf16_f32 v42, v100, v101
  v_cvt_pk_bf16_f32 v43, v102, v103
  s_add_u32 s46, s45, 32768
  buffer_store_dwordx2 v[42:43], v91, s[20:23], s46 offen sc1
  v_fma_f32 v104, v92, v168, v104
  v_fma_f32 v105, v92, v169, v105
  v_fma_f32 v106, v92, v170, v106
  v_fma_f32 v107, v92, v171, v107
  v_mul_f32 v104, v104, v93
  v_mul_f32 v105, v105, v93
  v_mul_f32 v106, v106, v93
  v_mul_f32 v107, v107, v93
  v_cvt_pk_bf16_f32 v44, v104, v105
  v_cvt_pk_bf16_f32 v45, v106, v107
  s_add_u32 s46, s45, 65536
  buffer_store_dwordx2 v[44:45], v91, s[20:23], s46 offen sc1
  v_fma_f32 v108, v92, v172, v108
  v_fma_f32 v109, v92, v173, v109
  v_fma_f32 v110, v92, v174, v110
  v_fma_f32 v111, v92, v175, v111
  v_mul_f32 v108, v108, v93
  v_mul_f32 v109, v109, v93
  v_mul_f32 v110, v110, v93
  v_mul_f32 v111, v111, v93
  v_cvt_pk_bf16_f32 v46, v108, v109
  v_cvt_pk_bf16_f32 v47, v110, v111
  s_add_u32 s46, s45, 98304
  buffer_store_dwordx2 v[46:47], v91, s[20:23], s46 offen sc1
  s_waitcnt lgkmcnt(8)
  v_fma_f32 v112, v92, v176, v112
  v_fma_f32 v113, v92, v177, v113
  v_fma_f32 v114, v92, v178, v114
  v_fma_f32 v115, v92, v179, v115
  v_mul_f32 v112, v112, v93
  v_mul_f32 v113, v113, v93
  v_mul_f32 v114, v114, v93
  v_mul_f32 v115, v115, v93
  v_cvt_pk_bf16_f32 v48, v112, v113
  v_cvt_pk_bf16_f32 v49, v114, v115
  s_add_u32 s46, s45, 131072
  buffer_store_dwordx2 v[48:49], v91, s[20:23], s46 offen sc1
  v_fma_f32 v116, v92, v180, v116
  v_fma_f32 v117, v92, v181, v117
  v_fma_f32 v118, v92, v182, v118
  v_fma_f32 v119, v92, v183, v119
  v_mul_f32 v116, v116, v93
  v_mul_f32 v117, v117, v93
  v_mul_f32 v118, v118, v93
  v_mul_f32 v119, v119, v93
  v_cvt_pk_bf16_f32 v50, v116, v117
  v_cvt_pk_bf16_f32 v51, v118, v119
  s_add_u32 s46, s45, 163840
  buffer_store_dwordx2 v[50:51], v91, s[20:23], s46 offen sc1
  v_fma_f32 v120, v92, v184, v120
  v_fma_f32 v121, v92, v185, v121
  v_fma_f32 v122, v92, v186, v122
  v_fma_f32 v123, v92, v187, v123
  v_mul_f32 v120, v120, v93
  v_mul_f32 v121, v121, v93
  v_mul_f32 v122, v122, v93
  v_mul_f32 v123, v123, v93
  v_cvt_pk_bf16_f32 v52, v120, v121
  v_cvt_pk_bf16_f32 v53, v122, v123
  s_add_u32 s46, s45, 196608
  buffer_store_dwordx2 v[52:53], v91, s[20:23], s46 offen sc1
  v_fma_f32 v124, v92, v188, v124
  v_fma_f32 v125, v92, v189, v125
  v_fma_f32 v126, v92, v190, v126
  v_fma_f32 v127, v92, v191, v127
  v_mul_f32 v124, v124, v93
  v_mul_f32 v125, v125, v93
  v_mul_f32 v126, v126, v93
  v_mul_f32 v127, v127, v93
  v_cvt_pk_bf16_f32 v54, v124, v125
  v_cvt_pk_bf16_f32 v55, v126, v127
  s_add_u32 s46, s45, 229376
  buffer_store_dwordx2 v[54:55], v91, s[20:23], s46 offen sc1
  s_waitcnt lgkmcnt(4)
  v_fma_f32 v128, v92, v192, v128
  v_fma_f32 v129, v92, v193, v129
  v_fma_f32 v130, v92, v194, v130
  v_fma_f32 v131, v92, v195, v131
  v_mul_f32 v128, v128, v93
  v_mul_f32 v129, v129, v93
  v_mul_f32 v130, v130, v93
  v_mul_f32 v131, v131, v93
  v_cvt_pk_bf16_f32 v40, v128, v129
  v_cvt_pk_bf16_f32 v41, v130, v131
  s_add_u32 s46, s45, 262144
  buffer_store_dwordx2 v[40:41], v91, s[20:23], s46 offen sc1
  v_fma_f32 v132, v92, v196, v132
  v_fma_f32 v133, v92, v197, v133
  v_fma_f32 v134, v92, v198, v134
  v_fma_f32 v135, v92, v199, v135
  v_mul_f32 v132, v132, v93
  v_mul_f32 v133, v133, v93
  v_mul_f32 v134, v134, v93
  v_mul_f32 v135, v135, v93
  v_cvt_pk_bf16_f32 v42, v132, v133
  v_cvt_pk_bf16_f32 v43, v134, v135
  s_add_u32 s46, s45, 294912
  buffer_store_dwordx2 v[42:43], v91, s[20:23], s46 offen sc1
  v_fma_f32 v136, v92, v200, v136
  v_fma_f32 v137, v92, v201, v137
  v_fma_f32 v138, v92, v202, v138
  v_fma_f32 v139, v92, v203, v139
  v_mul_f32 v136, v136, v93
  v_mul_f32 v137, v137, v93
  v_mul_f32 v138, v138, v93
  v_mul_f32 v139, v139, v93
  v_cvt_pk_bf16_f32 v44, v136, v137
  v_cvt_pk_bf16_f32 v45, v138, v139
  s_add_u32 s46, s45, 327680
  buffer_store_dwordx2 v[44:45], v91, s[20:23], s46 offen sc1
  v_fma_f32 v140, v92, v204, v140
  v_fma_f32 v141, v92, v205, v141
  v_fma_f32 v142, v92, v206, v142
  v_fma_f32 v143, v92, v207, v143
  v_mul_f32 v140, v140, v93
  v_mul_f32 v141, v141, v93
  v_mul_f32 v142, v142, v93
  v_mul_f32 v143, v143, v93
  v_cvt_pk_bf16_f32 v46, v140, v141
  v_cvt_pk_bf16_f32 v47, v142, v143
  s_add_u32 s46, s45, 360448
  buffer_store_dwordx2 v[46:47], v91, s[20:23], s46 offen sc1
  s_waitcnt lgkmcnt(0)
  v_fma_f32 v144, v92, v208, v144
  v_fma_f32 v145, v92, v209, v145
  v_fma_f32 v146, v92, v210, v146
  v_fma_f32 v147, v92, v211, v147
  v_mul_f32 v144, v144, v93
  v_mul_f32 v145, v145, v93
  v_mul_f32 v146, v146, v93
  v_mul_f32 v147, v147, v93
  v_cvt_pk_bf16_f32 v48, v144, v145
  v_cvt_pk_bf16_f32 v49, v146, v147
  s_add_u32 s46, s45, 393216
  buffer_store_dwordx2 v[48:49], v91, s[20:23], s46 offen sc1
  v_fma_f32 v148, v92, v212, v148
  v_fma_f32 v149, v92, v213, v149
  v_fma_f32 v150, v92, v214, v150
  v_fma_f32 v151, v92, v215, v151
  v_mul_f32 v148, v148, v93
  v_mul_f32 v149, v149, v93
  v_mul_f32 v150, v150, v93
  v_mul_f32 v151, v151, v93
  v_cvt_pk_bf16_f32 v50, v148, v149
  v_cvt_pk_bf16_f32 v51, v150, v151
  s_add_u32 s46, s45, 425984
  buffer_store_dwordx2 v[50:51], v91, s[20:23], s46 offen sc1
  v_fma_f32 v152, v92, v216, v152
  v_fma_f32 v153, v92, v217, v153
  v_fma_f32 v154, v92, v218, v154
  v_fma_f32 v155, v92, v219, v155
  v_mul_f32 v152, v152, v93
  v_mul_f32 v153, v153, v93
  v_mul_f32 v154, v154, v93
  v_mul_f32 v155, v155, v93
  v_cvt_pk_bf16_f32 v52, v152, v153
  v_cvt_pk_bf16_f32 v53, v154, v155
  s_add_u32 s46, s45, 458752
  buffer_store_dwordx2 v[52:53], v91, s[20:23], s46 offen sc1
  v_fma_f32 v156, v92, v220, v156
  v_fma_f32 v157, v92, v221, v157
  v_fma_f32 v158, v92, v222, v158
  v_fma_f32 v159, v92, v223, v159
  v_mul_f32 v156, v156, v93
  v_mul_f32 v157, v157, v93
  v_mul_f32 v158, v158, v93
  v_mul_f32 v159, v159, v93
  v_cvt_pk_bf16_f32 v54, v156, v157
  v_cvt_pk_bf16_f32 v55, v158, v159
  s_add_u32 s46, s45, 491520
  buffer_store_dwordx2 v[54:55], v91, s[20:23], s46 offen sc1
  s_waitcnt vmcnt(0)
  s_lshl_b32 s38, s33, 4
  s_add_u32 s38, s38, s34
  s_lshl_b32 s38, s38, 7
  s_add_u32 s38, s38, 589824
  v_mov_b32 v3, 156704
  v_mov_b32 v4, 1
  s_mov_b64 exec, 1
  ds_add_rtn_u32 v4, v3, v4
  s_waitcnt lgkmcnt(0)
  s_mov_b64 exec, -1
  v_readfirstlane_b32 s37, v4
  s_nop 3
  s_cmp_eq_u32 s37, 3
  s_cbranch_scc0 ag_10
  v_mov_b32 v3, s82
  v_mov_b32 v4, 0
  s_mov_b64 exec, 1
  buffer_store_dword v3, v4, s[16:19], s38 offen sc1
  s_mov_b64 exec, -1
ag_10:
  s_mul_i32 s31, s2, 3
  s_add_u32 s31, s31, s35
  s_cmp_lt_u32 s35, 3
  s_cselect_b32 s31, s31, 1000
  s_min_u32 s31, s31, 680
  s_min_u32 s28, s31, 679
  s_mul_i32 s29, s28, 6554
  s_lshr_b32 s29, s29, 16
  s_mul_i32 s30, s29, 10
  s_sub_u32 s30, s28, s30
  s_cmp_ge_u32 s29, 48
  s_cselect_b32 s52, s64, s72
  s_cselect_b32 s53, s65, s73
  s_mov_b32 s54, 819200
  s_cselect_b32 s54, s54, 1966080
  s_mov_b32 s55, 0x20000
  s_cselect_b64 s[56:57], -1, 0
  v_lshrrev_b32 v84, 3, v2
  v_and_b32 v85, 7, v2
  s_lshl_b32 s28, s30, 7
  v_lshl_add_u32 v85, v85, 4, s28
  s_sub_u32 s38, s29, 48
  s_lshl_b32 s58, s38, 2
  s_lshl_b32 s59, s29, 5
  v_lshrrev_b32 v86, 5, v2
  v_and_b32 v87, 3, v84
  v_add_u32 v88, 0, v86
  v_add_u32 v88, s58, v88
  v_mul_u32_u24 v89, 205, v88
  v_lshrrev_b32 v89, 10, v89
  v_mul_u32_u24 v90, 5, v89
  v_sub_u32 v90, v88, v90
  v_lshrrev_b32 v91, 1, v90
  v_and_b32 v92, 1, v90
  v_add_u32 v92, 0, v92
  v_cmp_eq_u32 vcc, 4, v90
  v_mov_b32 v88, 0
  v_mov_b32 v90, 4
  v_cndmask_b32 v91, v91, v88, vcc
  v_cndmask_b32 v92, v92, v90, vcc
  v_lshl_add_u32 v91, v89, 1, v91
  v_mul_u32_u24 v91, 20, v91
  v_lshl_add_u32 v91, v92, 2, v91
  v_add_u32 v91, v91, v87
  v_add_u32 v88, 0, v84
  v_add_u32 v88, s59, v88
  v_cndmask_b32 v91, v88, v91, s[56:57]
  v_mul_u32_u24 v91, 1280, v91
  v_add_u32 v91, v91, v85
  buffer_load_dwordx4 v[236:239], v91, s[52:55], 0 offen
  v_add_u32 v88, 2, v86
  v_add_u32 v88, s58, v88
  v_mul_u32_u24 v89, 205, v88
  v_lshrrev_b32 v89, 10, v89
  v_mul_u32_u24 v90, 5, v89
  v_sub_u32 v90, v88, v90
  v_lshrrev_b32 v91, 1, v90
  v_and_b32 v92, 1, v90
  v_add_u32 v92, 0, v92
  v_cmp_eq_u32 vcc, 4, v90
  v_mov_b32 v88, 0
  v_mov_b32 v90, 4
  v_cndmask_b32 v91, v91, v88, vcc
  v_cndmask_b32 v92, v92, v90, vcc
  v_lshl_add_u32 v91, v89, 1, v91
  v_mul_u32_u24 v91, 20, v91
  v_lshl_add_u32 v91, v92, 2, v91
  v_add_u32 v91, v91, v87
  v_add_u32 v88, 8, v84
  v_add_u32 v88, s59, v88
  v_cndmask_b32 v91, v88, v91, s[56:57]
  v_mul_u32_u24 v91, 1280, v91
  v_add_u32 v91, v91, v85
  buffer_load_dwordx4 v[240:243], v91, s[52:55], 0 offen
  v_add_u32 v88, 0, v86
  v_add_u32 v88, s58, v88
  v_mul_u32_u24 v89, 205, v88
  v_lshrrev_b32 v89, 10, v89
  v_mul_u32_u24 v90, 5, v89
  v_sub_u32 v90, v88, v90
  v_lshrrev_b32 v91, 1, v90
  v_and_b32 v92, 1, v90
  v_add_u32 v92, 2, v92
  v_cmp_eq_u32 vcc, 4, v90
  v_mov_b32 v88, 1
  v_mov_b32 v90, 4
  v_cndmask_b32 v91, v91, v88, vcc
  v_cndmask_b32 v92, v92, v90, vcc
  v_lshl_add_u32 v91, v89, 1, v91
  v_mul_u32_u24 v91, 20, v91
  v_lshl_add_u32 v91, v92, 2, v91
  v_add_u32 v91, v91, v87
  v_add_u32 v88, 16, v84
  v_add_u32 v88, s59, v88
  v_cndmask_b32 v91, v88, v91, s[56:57]
  v_mul_u32_u24 v91, 1280, v91
  v_add_u32 v91, v91, v85
  buffer_load_dwordx4 v[244:247], v91, s[52:55], 0 offen
  v_add_u32 v88, 2, v86
  v_add_u32 v88, s58, v88
  v_mul_u32_u24 v89, 205, v88
  v_lshrrev_b32 v89, 10, v89
  v_mul_u32_u24 v90, 5, v89
  v_sub_u32 v90, v88, v90
  v_lshrrev_b32 v91, 1, v90
  v_and_b32 v92, 1, v90
  v_add_u32 v92, 2, v92
  v_cmp_eq_u32 vcc, 4, v90
  v_mov_b32 v88, 1
  v_mov_b32 v90, 4
  v_cndmask_b32 v91, v91, v88, vcc
  v_cndmask_b32 v92, v92, v90, vcc
  v_lshl_add_u32 v91, v89, 1, v91
  v_mul_u32_u24 v91, 20, v91
  v_lshl_add_u32 v91, v92, 2, v91
  v_add_u32 v91, v91, v87
  v_add_u32 v88, 24, v84
  v_add_u32 v88, s59, v88
  v_cndmask_b32 v91, v88, v91, s[56:57]
  v_mul_u32_u24 v91, 1280, v91
  v_add_u32 v91, v91, v85
  buffer_load_dwordx4 v[248:251], v91, s[52:55], 0 offen
  v_mov_b32 v3, 156724
  s_mov_b32 s37, 0
lw_11:
  ds_read_b32 v4, v3
  s_waitcnt lgkmcnt(0)
  v_cmp_gt_u32 vcc, 4, v4
  s_cbranch_vccz lwd_12
  s_add_u32 s37, s37, 1
  s_cmp_lt_u32 s37, 640000
  s_cbranch_scc0 lwd_12
  s_sleep 1
  s_branch lw_11
lwd_12:
  s_mul_i32 s59, s35, 5120
  v_lshrrev_b32 v84, 3, v2
  v_mul_u32_u24 v84, 160, v84
  v_and_b32 v85, 7, v2
  v_lshl_add_u32 v84, v85, 4, v84
  v_add_u32 v84, s59, v84
  s_waitcnt vmcnt(0)
  ds_write_b128 v84, v[236:239] offset:0
  ds_write_b128 v84, v[240:243] offset:1280
  ds_write_b128 v84, v[244:247] offset:2560
  ds_write_b128 v84, v[248:251] offset:3840
  v_lshrrev_b32 v85, 2, v2
  v_mul_u32_u24 v85, 160, v85
  v_and_b32 v86, 3, v2
  v_lshl_add_u32 v85, v86, 3, v85
  v_add_u32 v85, s59, v85
  s_add_u32 s52, s80, 720896
  s_addc_u32 s53, s81, 0
  s_mov_b32 s54, 2785280
  s_mov_b32 s55, 0x20000
  s_waitcnt lgkmcnt(0)
  ds_read_b64_tr_b16 v[236:237], v85 offset:0
  ds_read_b64_tr_b16 v[238:239], v85 offset:2560
  ds_read_b64_tr_b16 v[240:241], v85 offset:32
  ds_read_b64_tr_b16 v[242:243], v85 offset:2592
  ds_read_b64_tr_b16 v[244:245], v85 offset:64
  ds_read_b64_tr_b16 v[246:247], v85 offset:2624
  ds_read_b64_tr_b16 v[248:249], v85 offset:96
  ds_read_b64_tr_b16 v[250:251], v85 offset:2656
  v_lshlrev_b32 v86, 4, v2
  s_waitcnt lgkmcnt(0)
  s_cmp_lt_u32 s31, 680
  s_cbranch_scc0 cst_1
  s_lshl_b32 s37, s30, 2
  s_add_u32 s37, s37, 0
  s_mul_i32 s38, s37, 205
  s_lshr_b32 s38, s38, 10
  s_mul_i32 s39, s38, 5
  s_sub_u32 s39, s37, s39
  s_mul_i32 s38, s38, 68
  s_add_u32 s38, s38, s29
  s_mul_i32 s38, s38, 5
  s_add_u32 s38, s38, s39
  s_lshl_b32 s38, s38, 10
  buffer_store_dwordx4 v[236:239], v86, s[52:55], s38 offen sc1
  s_lshl_b32 s37, s30, 2
  s_add_u32 s37, s37, 1
  s_mul_i32 s38, s37, 205
  s_lshr_b32 s38, s38, 10
  s_mul_i32 s39, s38, 5
  s_sub_u32 s39, s37, s39
  s_mul_i32 s38, s38, 68
  s_add_u32 s38, s38, s29
  s_mul_i32 s38, s38, 5
  s_add_u32 s38, s38, s39
  s_lshl_b32 s38, s38, 10
  buffer_store_dwordx4 v[240:243], v86, s[52:55], s38 offen sc1
  s_lshl_b32 s37, s30, 2
  s_add_u32 s37, s37, 2
  s_mul_i32 s38, s37, 205
  s_lshr_b32 s38, s38, 10
  s_mul_i32 s39, s38, 5
  s_sub_u32 s39, s37, s39
  s_mul_i32 s38, s38, 68
  s_add_u32 s38, s38, s29
  s_mul_i32 s38, s38, 5
  s_add_u32 s38, s38, s39
  s_lshl_b32 s38, s38, 10
  buffer_store_dwordx4 v[244:247], v86, s[52:55], s38 offen sc1
  s_lshl_b32 s37, s30, 2
  s_add_u32 s37, s37, 3
  s_mul_i32 s38, s37, 205
  s_lshr_b32 s38, s38, 10
  s_mul_i32 s39, s38, 5
  s_sub_u32 s39, s37, s39
  s_mul_i32 s38, s38, 68
  s_add_u32 s38, s38, s29
  s_mul_i32 s38, s38, 5
  s_add_u32 s38, s38, s39
  s_lshl_b32 s38, s38, 10
  buffer_store_dwordx4 v[248:251], v86, s[52:55], s38 offen sc1
cst_1:
  s_mov_b32 s22, 7864320
  s_add_u32 s24, s80, 11534336
  s_addc_u32 s25, s81, 0
  s_mov_b32 s26, 8912896
  s_mov_b32 s27, 0x20000
  s_mul_i32 s37, s34, 10
  s_lshr_b32 s38, s37, 5
  s_add_u32 s37, s37, 9
  s_lshr_b32 s39, s37, 5
  v_min_u32 v3, 13, v2
  v_mul_u32_u24 v4, 43, v3
  v_lshrrev_b32 v4, 8, v4
  v_mul_u32_u24 v5, 6, v4
  v_sub_u32 v5, v3, v5
  v_mul_u32_u24 v6, 86, v5
  v_lshrrev_b32 v6, 8, v6
  v_mul_u32_u24 v7, 3, v6
  v_sub_u32 v7, v5, v7
  v_cmp_eq_u32 vcc, 2, v4
  v_mov_b32 v8, 0
  s_nop 0
  v_cndmask_b32 v6, v6, v5, vcc
  v_cndmask_b32 v7, v7, v8, vcc
  v_add_u32 v8, 1, v4
  v_mul_u32_u24 v8, 5, v8
  v_cmp_eq_u32 vcc, 15, v8
  v_mov_b32 v9, 0
  s_nop 0
  v_cndmask_b32 v8, v8, v9, vcc
  v_mov_b32 v9, s38
  v_mov_b32 v20, s39
  v_cmp_eq_u32 vcc, 0, v6
  s_nop 1
  v_cndmask_b32 v9, v20, v9, vcc
  v_add_u32 v8, v8, v9
  v_sub_u32 v9, s33, v7
  v_max_i32 v9, 0, v9
  v_lshl_add_u32 v8, v9, 4, v8
  v_lshlrev_b32 v8, 7, v8
  v_add_u32 v8, 589824, v8
  v_mov_b32 v10, 0x3f80
  v_mov_b32 v11, 0
  v_lshlrev_b32 v4, 3, v0
  ds_write_b64 v4, v[10:11] offset:62176
  v_add_u32 v5, 65408, v4
  ds_write_b64 v5, v[10:11]
  v_min_u32 v6, 127, v0
  v_lshlrev_b32 v6, 3, v6
  ds_write_b64 v6, v[10:11] offset:64224
  v_add_u32 v6, 65408, v6
  ds_write_b64 v6, v[10:11] offset:2048
  s_cmp_lt_u32 s33, 2
  s_cselect_b32 s56, 0x40000000, 0
  s_cmp_lt_u32 s33, 1
  s_cselect_b32 s57, 0x40000000, 0
  s_lshl_b32 s40, s33, 10
  s_sub_u32 s40, s40, 2048
  s_mul_i32 s41, s34, 163840
  s_add_u32 s40, s40, s41
  s_add_u32 s40, s40, 2621440
  s_lshl_b32 s41, s35, 14
  s_add_u32 s28, s40, s41
  s_mul_i32 s42, s35, 3104
  s_add_u32 s29, s28, 65536
  s_cmp_ge_u32 s35, 2
  s_cselect_b32 s45, 2457600, 0
  s_add_u32 s30, s28, s45
  s_add_u32 s30, s30, 131072
  s_add_u32 s31, s28, 2654208
  s_waitcnt vmcnt(0) lgkmcnt(0)
  s_lshl_b32 s38, s2, 7
  s_add_u32 s38, s38, 688128
  v_mov_b32 v3, 156708
  v_mov_b32 v4, 1
  s_mov_b64 exec, 1
  ds_add_rtn_u32 v4, v3, v4
  s_waitcnt lgkmcnt(0)
  s_mov_b64 exec, -1
  v_readfirstlane_b32 s37, v4
  s_nop 3
  s_cmp_eq_u32 s37, 3
  s_cbranch_scc0 ag_13
  v_mov_b32 v3, s82
  v_mov_b32 v4, 0
  s_mov_b64 exec, 1
  buffer_store_dword v3, v4, s[16:19], s38 offen sc1
  s_mov_b64 exec, -1
ag_13:
  v_mov_b32 v3, 156732
  s_mov_b32 s37, 0
lw_14:
  ds_read_b32 v4, v3
  s_waitcnt lgkmcnt(0)
  v_cmp_gt_u32 vcc, 4, v4
  s_cbranch_vccz lwd_15
  s_add_u32 s37, s37, 1
  s_cmp_lt_u32 s37, 640000
  s_cbranch_scc0 lwd_15
  s_sleep 2
  s_branch lw_14
lwd_15:
  v_mov_b32 v20, 156688
  s_cmp_eq_u32 s35, 0
  s_cbranch_scc0 pw_16
  s_mov_b32 s37, 0
poll_19:
  buffer_load_dword v9, v8, s[16:19], 0 offen sc1
  s_waitcnt vmcnt(0)
  v_cmp_ne_u32 vcc, s82, v9
  s_cbranch_vccz polld_20
  s_add_u32 s37, s37, 1
  s_cmp_lt_u32 s37, 20000
  s_cbranch_scc0 polld_20
  s_sleep 4
  s_branch poll_19
polld_20:
  v_mov_b32 v9, s82
  ds_write_b32 v20, v9
  s_waitcnt lgkmcnt(0)
  s_branch pd_17
pw_16:
  s_mov_b32 s37, 0
pl_18:
  ds_read_b32 v9, v20
  s_waitcnt lgkmcnt(0)
  v_cmp_ne_u32 vcc, s82, v9
  s_cbranch_vccz pd_17
  s_add_u32 s37, s37, 1
  s_cmp_lt_u32 s37, 160000
  s_cbranch_scc0 pd_17
  s_sleep 2
  s_branch pl_18
pd_17:
  v_lshlrev_b32 v3, 4, v2
  s_add_u32 m0, s42, 0
  s_add_u32 s47, s28, 0
  s_add_u32 s47, s47, s56
  buffer_load_dwordx4 v3, s[20:23], s47 offen sc1 lds
  s_add_u32 m0, s42, 1024
  s_add_u32 s47, s28, 1024
  s_add_u32 s47, s47, s57
  buffer_load_dwordx4 v3, s[20:23], s47 offen sc1 lds
  s_add_u32 m0, s42, 2048
  s_add_u32 s47, s28, 2048
  buffer_load_dwordx4 v3, s[20:23], s47 offen sc1 lds
  s_add_u32 m0, s42, 12416
  s_add_u32 s47, s29, 0
  s_add_u32 s47, s47, s56
  buffer_load_dwordx4 v3, s[20:23], s47 offen sc1 lds
  s_add_u32 m0, s42, 13440
  s_add_u32 s47, s29, 1024
  s_add_u32 s47, s47, s57
  buffer_load_dwordx4 v3, s[20:23], s47 offen sc1 lds
  s_add_u32 m0, s42, 14464
  s_add_u32 s47, s29, 2048
  buffer_load_dwordx4 v3, s[20:23], s47 offen sc1 lds
  s_add_u32 m0, s42, 24832
  s_add_u32 s47, s30, 0
  s_add_u32 s47, s47, s56
  buffer_load_dwordx4 v3, s[20:23], s47 offen sc1 lds
  s_add_u32 m0, s42, 25856
  s_add_u32 s47, s30, 1024
  s_add_u32 s47, s47, s57
  buffer_load_dwordx4 v3, s[20:23], s47 offen sc1 lds
  s_add_u32 m0, s42, 26880
  s_add_u32 s47, s30, 2048
  buffer_load_dwordx4 v3, s[20:23], s47 offen sc1 lds
  s_add_u32 m0, s42, 37248
  s_add_u32 s47, s31, 0
  s_add_u32 s47, s47, s56
  buffer_load_dwordx4 v3, s[20:23], s47 offen sc1 lds
  s_add_u32 m0, s42, 38272
  s_add_u32 s47, s31, 1024
  s_add_u32 s47, s47, s57
  buffer_load_dwordx4 v3, s[20:23], s47 offen sc1 lds
  s_add_u32 m0, s42, 39296
  s_add_u32 s47, s31, 2048
  buffer_load_dwordx4 v3, s[20:23], s47 offen sc1 lds
  s_add_u32 m0, s42, 49664
  s_add_u32 s47, s31, 65536
  s_add_u32 s47, s47, s56
  buffer_load_dwordx4 v3, s[20:23], s47 offen sc1 lds
  s_add_u32 m0, s42, 50688
  s_add_u32 s47, s31, 66560
  s_add_u32 s47, s47, s57
  buffer_load_dwordx4 v3, s[20:23], s47 offen sc1 lds
  s_add_u32 m0, s42, 51712
  s_add_u32 s47, s31, 67584
  buffer_load_dwordx4 v3, s[20:23], s47 offen sc1 lds
  v_and_b32 v5, 31, v2
  v_lshrrev_b32 v6, 5, v2
  s_lshl_b32 s40, s33, 7
  s_lshl_b32 s41, s35, 5
  s_add_u32 s40, s40, s41
  v_add_u32 v7, s40, v5
  v_lshlrev_b32 v7, 3, v7
  v_lshl_add_u32 v8, v6, 15, v7
  s_mul_i32 s41, s34, 10
  s_add_u32 s41, s41, 0
  s_lshl_b32 s41, s41, 14
  buffer_load_dwordx2 v[12:13], v8, s[20:23], s41 offen sc1
  s_add_u32 s42, s41, 16384
  buffer_load_dwordx2 v[14:15], v8, s[20:23], s42 offen sc1
  s_add_u32 s42, s41, 65536
  buffer_load_dwordx2 v[16:17], v7, s[20:23], s42 offen sc1
  v_mov_b32 v18, 0
  v_mov_b32 v19, 0
  s_mul_i32 s41, s34, 10
  s_add_u32 s41, s41, 5
  s_lshl_b32 s41, s41, 14
  buffer_load_dwordx2 v[232:233], v8, s[20:23], s41 offen sc1
  s_add_u32 s42, s41, 16384
  buffer_load_dwordx2 v[234:235], v8, s[20:23], s42 offen sc1
  s_add_u32 s42, s41, 65536
  buffer_load_dwordx2 v[236:237], v7, s[20:23], s42 offen sc1
  v_mov_b32 v238, 0
  v_mov_b32 v239, 0
  s_waitcnt vmcnt(0) lgkmcnt(0)
  v_cmp_eq_u32 vcc, 0, v6
  s_nop 1
  v_cndmask_b32 v16, 0, v16, vcc
  v_cndmask_b32 v17, 0, v17, vcc
  v_cndmask_b32 v236, 0, v236, vcc
  v_cndmask_b32 v237, 0, v237, vcc
  v_mov_b32 v9, 156720
  v_mov_b32 v10, 1
  s_mov_b64 exec, 1
  ds_add_u32 v9, v10
  s_mov_b64 exec, -1
  s_mov_b32 s37, 0
kv_21:
  ds_read_b32 v10, v9
  s_waitcnt lgkmcnt(0)
  v_cmp_ne_u32 vcc, 4, v10
  s_cbranch_vccz kvd_22
  s_add_u32 s37, s37, 1
  s_cmp_lt_u32 s37, 160000
  s_cbranch_scc0 kvd_22
  s_sleep 1
  s_branch kv_21
kvd_22:
  s_setprio 1
  s_lshl_b32 s43, s35, 8
  v_lshlrev_b32 v9, 3, v5
  v_add_u32 v9, s43, v9
  v_mul_u32_u24 v20, 6208, v6
  v_add_u32 v20, v20, v9
  v_add_u32 v21, 12416, v9
  s_lshl_b32 s46, s33, 2
  s_add_u32 s46, s46, s35
  s_sub_i32 s46, 8, s46
  s_max_i32 s46, s46, 0
  s_cmp_gt_u32 s46, 0
  s_cselect_b32 s47, 0xff7f, 0
  v_mov_b32 v38, s47
  v_mov_b32 v39, 0
  s_cmp_gt_u32 s46, 1
  s_cselect_b32 s47, 0xff7f, 0
  v_mov_b32 v46, s47
  v_mov_b32 v47, 0
  s_cmp_gt_u32 s46, 2
  s_cselect_b32 s47, 0xff7f, 0
  v_mov_b32 v54, s47
  v_mov_b32 v55, 0
  s_cmp_gt_u32 s46, 3
  s_cselect_b32 s47, 0xff7f, 0
  v_mov_b32 v62, s47
  v_mov_b32 v63, 0
  s_cmp_gt_u32 s46, 4
  s_cselect_b32 s47, 0xff7f, 0
  v_mov_b32 v70, s47
  v_mov_b32 v71, 0
  s_cmp_gt_u32 s46, 5
  s_cselect_b32 s47, 0xff7f, 0
  v_mov_b32 v78, s47
  v_mov_b32 v79, 0
  s_cmp_gt_u32 s46, 6
  s_cselect_b32 s47, 0xff7f, 0
  v_mov_b32 v86, s47
  v_mov_b32 v87, 0
  s_cmp_gt_u32 s46, 7
  s_cselect_b32 s47, 0xff7f, 0
  v_mov_b32 v94, s47
  v_mov_b32 v95, 0
  v_mov_b32 v102, 0
  v_mov_b32 v103, 0
  v_cmp_eq_u32 vcc, 0, v6
  v_mov_b32 v7, 0x3f80
  s_nop 0
  v_cndmask_b32 v18, 0, v7, vcc
  v_mov_b32 v238, v18
  ds_read_b64 v[32:33], v20 offset:0
  ds_read_b64 v[34:35], v20 offset:3104
  ds_read_b64 v[36:37], v21 offset:0
  ds_read_b64 v[40:41], v20 offset:256
  ds_read_b64 v[42:43], v20 offset:3360
  ds_read_b64 v[44:45], v21 offset:256
  ds_read_b64 v[48:49], v20 offset:512
  ds_read_b64 v[50:51], v20 offset:3616
  ds_read_b64 v[52:53], v21 offset:512
  ds_read_b64 v[56:57], v20 offset:768
  ds_read_b64 v[58:59], v20 offset:3872
  ds_read_b64 v[60:61], v21 offset:768
  ds_read_b64 v[64:65], v20 offset:1024
  ds_read_b64 v[66:67], v20 offset:4128
  ds_read_b64 v[68:69], v21 offset:1024
  ds_read_b64 v[72:73], v20 offset:1280
  ds_read_b64 v[74:75], v20 offset:4384
  ds_read_b64 v[76:77], v21 offset:1280
  ds_read_b64 v[80:81], v20 offset:1536
  ds_read_b64 v[82:83], v20 offset:4640
  ds_read_b64 v[84:85], v21 offset:1536
  ds_read_b64 v[88:89], v20 offset:1792
  ds_read_b64 v[90:91], v20 offset:4896
  ds_read_b64 v[92:93], v21 offset:1792
  ds_read_b64 v[96:97], v20 offset:2048
  ds_read_b64 v[98:99], v20 offset:5152
  ds_read_b64 v[100:101], v21 offset:2048
  v_bfe_u32 v22, v2, 4, 1
  v_and_b32 v23, 3, v2
  v_bfe_u32 v24, v2, 2, 2
  v_lshl_add_u32 v24, v6, 2, v24
  v_lshlrev_b32 v24, 3, v24
  v_add_u32 v24, s43, v24
  v_lshl_add_u32 v25, v22, 2, v23
  v_mul_u32_u24 v26, 3104, v25
  v_add_u32 v26, 31040, v26
  v_cmp_lt_u32 vcc, 4, v25
  v_mov_b32 v7, 62176
  v_mov_b32 v8, 65408
  v_cndmask_b32 v22, v26, v7, vcc
  v_add_u32 v26, 15520, v26
  v_cndmask_b32 v23, v26, v8, vcc
  v_add_u32 v22, v22, v24
  v_add_u32 v23, v23, v24
  v_mov_b32 v28, 0xf149f2ca
  v_mov_b32 v27, 0
  v_lshlrev_b32 v29, 2, v6
  v_sub_u32 v29, v5, v29
  v_cmp_le_i32 vcc, 0, v29
  s_nop 1
  v_cndmask_b32 v216, v28, v27, vcc
  v_cndmask_b32 v200, v27, v28, vcc
  v_cmp_le_i32 vcc, 1, v29
  s_nop 1
  v_cndmask_b32 v217, v28, v27, vcc
  v_cndmask_b32 v201, v27, v28, vcc
  v_cmp_le_i32 vcc, 2, v29
  s_nop 1
  v_cndmask_b32 v218, v28, v27, vcc
  v_cndmask_b32 v202, v27, v28, vcc
  v_cmp_le_i32 vcc, 3, v29
  s_nop 1
  v_cndmask_b32 v219, v28, v27, vcc
  v_cndmask_b32 v203, v27, v28, vcc
  v_cmp_le_i32 vcc, 8, v29
  s_nop 1
  v_cndmask_b32 v220, v28, v27, vcc
  v_cndmask_b32 v204, v27, v28, vcc
  v_cmp_le_i32 vcc, 9, v29
  s_nop 1
  v_cndmask_b32 v221, v28, v27, vcc
  v_cndmask_b32 v205, v27, v28, vcc
  v_cmp_le_i32 vcc, 10, v29
  s_nop 1
  v_cndmask_b32 v222, v28, v27, vcc
  v_cndmask_b32 v206, v27, v28, vcc
  v_cmp_le_i32 vcc, 11, v29
  s_nop 1
  v_cndmask_b32 v223, v28, v27, vcc
  v_cndmask_b32 v207, v27, v28, vcc
  v_cmp_le_i32 vcc, 16, v29
  s_nop 1
  v_cndmask_b32 v224, v28, v27, vcc
  v_cndmask_b32 v208, v27, v28, vcc
  v_cmp_le_i32 vcc, 17, v29
  s_nop 1
  v_cndmask_b32 v225, v28, v27, vcc
  v_cndmask_b32 v209, v27, v28, vcc
  v_cmp_le_i32 vcc, 18, v29
  s_nop 1
  v_cndmask_b32 v226, v28, v27, vcc
  v_cndmask_b32 v210, v27, v28, vcc
  v_cmp_le_i32 vcc, 19, v29
  s_nop 1
  v_cndmask_b32 v227, v28, v27, vcc
  v_cndmask_b32 v211, v27, v28, vcc
  v_cmp_le_i32 vcc, 24, v29
  s_nop 1
  v_cndmask_b32 v228, v28, v27, vcc
  v_cndmask_b32 v212, v27, v28, vcc
  v_cmp_le_i32 vcc, 25, v29
  s_nop 1
  v_cndmask_b32 v229, v28, v27, vcc
  v_cndmask_b32 v213, v27, v28, vcc
  v_cmp_le_i32 vcc, 26, v29
  s_nop 1
  v_cndmask_b32 v230, v28, v27, vcc
  v_cndmask_b32 v214, v27, v28, vcc
  v_cmp_le_i32 vcc, 27, v29
  s_nop 1
  v_cndmask_b32 v231, v28, v27, vcc
  v_cndmask_b32 v215, v27, v28, vcc
  v_bfe_u32 v24, v2, 4, 1
  v_lshlrev_b32 v24, 10, v24
  v_and_b32 v25, 15, v2
  v_lshl_add_u32 v24, v25, 4, v24
  s_lshl_b32 s42, s33, 1
  s_lshr_b32 s43, s35, 1
  s_add_u32 s42, s42, s43
  s_mul_i32 s42, s42, 68
  s_add_u32 s42, s42, 48
  s_lshl_b32 s42, s42, 12
  s_and_b32 s43, s35, 1
  s_lshl_b32 s43, s43, 11
  s_add_u32 s42, s42, s43
  s_mul_i32 s40, s34, 5
  ds_read_b64_tr_b16 v[240:241], v22 offset:0
  ds_read_b64_tr_b16 v[242:243], v22 offset:64
  ds_read_b64_tr_b16 v[244:245], v22 offset:128
  ds_read_b64_tr_b16 v[246:247], v22 offset:192
  s_waitcnt lgkmcnt(15)
  v_mfma_f32_32x32x16_bf16 v[104:119], v[32:35], v[12:15], v[200:215]
  v_mfma_f32_32x32x16_bf16 v[104:119], v[36:39], v[16:19], v[104:119]
  s_waitcnt lgkmcnt(15)
  v_mfma_f32_32x32x16_bf16 v[120:135], v[40:43], v[12:15], 0
  v_mfma_f32_32x32x16_bf16 v[120:135], v[44:47], v[16:19], v[120:135]
  ds_read_b64_tr_b16 v[248:249], v22 offset:256
  ds_read_b64_tr_b16 v[250:251], v22 offset:320
  ds_read_b64_tr_b16 v[252:253], v22 offset:384
  ds_read_b64_tr_b16 v[254:255], v22 offset:448
  s_nop 5
  s_waitcnt lgkmcnt(15)
  v_exp_f32 v104, v104
  v_exp_f32 v105, v105
  v_exp_f32 v106, v106
  v_exp_f32 v107, v107
  v_mfma_f32_32x32x16_bf16 v[136:151], v[48:51], v[12:15], 0
  v_exp_f32 v108, v108
  v_exp_f32 v109, v109
  v_exp_f32 v110, v110
  v_exp_f32 v111, v111
  v_mfma_f32_32x32x16_bf16 v[136:151], v[52:55], v[16:19], v[136:151]
  v_exp_f32 v112, v112
  v_exp_f32 v113, v113
  v_exp_f32 v114, v114
  v_exp_f32 v115, v115
  v_exp_f32 v116, v116
  v_exp_f32 v117, v117
  v_exp_f32 v118, v118
  v_exp_f32 v119, v119
  v_cvt_pk_bf16_f32 v152, v104, v105
  v_cvt_pk_bf16_f32 v153, v106, v107
  v_cvt_pk_bf16_f32 v154, v108, v109
  v_cvt_pk_bf16_f32 v155, v110, v111
  v_cvt_pk_bf16_f32 v156, v112, v113
  v_cvt_pk_bf16_f32 v157, v114, v115
  v_cvt_pk_bf16_f32 v158, v116, v117
  v_cvt_pk_bf16_f32 v159, v118, v119
  s_waitcnt lgkmcnt(4)
  s_waitcnt lgkmcnt(15)
  v_exp_f32 v120, v120
  v_exp_f32 v121, v121
  v_exp_f32 v122, v122
  v_exp_f32 v123, v123
  v_mfma_f32_32x32x16_bf16 v[168:183], v[240:243], v[152:155], 0
  v_exp_f32 v124, v124
  v_exp_f32 v125, v125
  v_exp_f32 v126, v126
  v_exp_f32 v127, v127
  v_mfma_f32_32x32x16_bf16 v[104:119], v[56:59], v[12:15], 0
  v_exp_f32 v128, v128
  v_exp_f32 v129, v129
  v_exp_f32 v130, v130
  v_exp_f32 v131, v131
  v_mfma_f32_32x32x16_bf16 v[168:183], v[244:247], v[156:159], v[168:183]
  v_exp_f32 v132, v132
  v_exp_f32 v133, v133
  v_exp_f32 v134, v134
  v_exp_f32 v135, v135
  v_mfma_f32_32x32x16_bf16 v[104:119], v[60:63], v[16:19], v[104:119]
  ds_read_b64_tr_b16 v[240:241], v22 offset:512
  ds_read_b64_tr_b16 v[242:243], v22 offset:576
  ds_read_b64_tr_b16 v[244:245], v22 offset:640
  ds_read_b64_tr_b16 v[246:247], v22 offset:704
  v_cvt_pk_bf16_f32 v160, v120, v121
  v_cvt_pk_bf16_f32 v161, v122, v123
  v_cvt_pk_bf16_f32 v162, v124, v125
  v_cvt_pk_bf16_f32 v163, v126, v127
  v_cvt_pk_bf16_f32 v164, v128, v129
  v_cvt_pk_bf16_f32 v165, v130, v131
  v_cvt_pk_bf16_f32 v166, v132, v133
  v_cvt_pk_bf16_f32 v167, v134, v135
  s_waitcnt lgkmcnt(4)
  s_waitcnt lgkmcnt(15)
  v_exp_f32 v136, v136
  v_exp_f32 v137, v137
  v_exp_f32 v138, v138
  v_exp_f32 v139, v139
  v_mfma_f32_32x32x16_bf16 v[168:183], v[248:251], v[160:163], v[168:183]
  v_exp_f32 v140, v140
  v_exp_f32 v141, v141
  v_exp_f32 v142, v142
  v_exp_f32 v143, v143
  v_mfma_f32_32x32x16_bf16 v[120:135], v[64:67], v[12:15], 0
  v_exp_f32 v144, v144
  v_exp_f32 v145, v145
  v_exp_f32 v146, v146
  v_exp_f32 v147, v147
  v_mfma_f32_32x32x16_bf16 v[168:183], v[252:255], v[164:167], v[168:183]
  v_exp_f32 v148, v148
  v_exp_f32 v149, v149
  v_exp_f32 v150, v150
  v_exp_f32 v151, v151
  v_mfma_f32_32x32x16_bf16 v[120:135], v[68:71], v[16:19], v[120:135]
  ds_read_b64_tr_b16 v[248:249], v22 offset:768
  ds_read_b64_tr_b16 v[250:251], v22 offset:832
  ds_read_b64_tr_b16 v[252:253], v22 offset:896
  ds_read_b64_tr_b16 v[254:255], v22 offset:960
  v_cvt_pk_bf16_f32 v152, v136, v137
  v_cvt_pk_bf16_f32 v153, v138, v139
  v_cvt_pk_bf16_f32 v154, v140, v141
  v_cvt_pk_bf16_f32 v155, v142, v143
  v_cvt_pk_bf16_f32 v156, v144, v145
  v_cvt_pk_bf16_f32 v157, v146, v147
  v_cvt_pk_bf16_f32 v158, v148, v149
  v_cvt_pk_bf16_f32 v159, v150, v151
  s_waitcnt lgkmcnt(4)
  s_waitcnt lgkmcnt(15)
  v_exp_f32 v104, v104
  v_exp_f32 v105, v105
  v_exp_f32 v106, v106
  v_exp_f32 v107, v107
  v_mfma_f32_32x32x16_bf16 v[168:183], v[240:243], v[152:155], v[168:183]
  v_exp_f32 v108, v108
  v_exp_f32 v109, v109
  v_exp_f32 v110, v110
  v_exp_f32 v111, v111
  v_mfma_f32_32x32x16_bf16 v[136:151], v[72:75], v[12:15], 0
  v_exp_f32 v112, v112
  v_exp_f32 v113, v113
  v_exp_f32 v114, v114
  v_exp_f32 v115, v115
  v_mfma_f32_32x32x16_bf16 v[168:183], v[244:247], v[156:159], v[168:183]
  v_exp_f32 v116, v116
  v_exp_f32 v117, v117
  v_exp_f32 v118, v118
  v_exp_f32 v119, v119
  v_mfma_f32_32x32x16_bf16 v[136:151], v[76:79], v[16:19], v[136:151]
  ds_read_b64_tr_b16 v[240:241], v22 offset:1024
  ds_read_b64_tr_b16 v[242:243], v22 offset:1088
  ds_read_b64_tr_b16 v[244:245], v22 offset:1152
  ds_read_b64_tr_b16 v[246:247], v22 offset:1216
  v_cvt_pk_bf16_f32 v160, v104, v105
  v_cvt_pk_bf16_f32 v161, v106, v107
  v_cvt_pk_bf16_f32 v162, v108, v109
  v_cvt_pk_bf16_f32 v163, v110, v111
  v_cvt_pk_bf16_f32 v164, v112, v113
  v_cvt_pk_bf16_f32 v165, v114, v115
  v_cvt_pk_bf16_f32 v166, v116, v117
  v_cvt_pk_bf16_f32 v167, v118, v119
  s_waitcnt lgkmcnt(4)
  s_waitcnt lgkmcnt(15)
  v_exp_f32 v120, v120
  v_exp_f32 v121, v121
  v_exp_f32 v122, v122
  v_exp_f32 v123, v123
  v_mfma_f32_32x32x16_bf16 v[168:183], v[248:251], v[160:163], v[168:183]
  v_exp_f32 v124, v124
  v_exp_f32 v125, v125
  v_exp_f32 v126, v126
  v_exp_f32 v127, v127
  v_mfma_f32_32x32x16_bf16 v[104:119], v[80:83], v[12:15], 0
  v_exp_f32 v128, v128
  v_exp_f32 v129, v129
  v_exp_f32 v130, v130
  v_exp_f32 v131, v131
  v_mfma_f32_32x32x16_bf16 v[168:183], v[252:255], v[164:167], v[168:183]
  v_exp_f32 v132, v132
  v_exp_f32 v133, v133
  v_exp_f32 v134, v134
  v_exp_f32 v135, v135
  v_mfma_f32_32x32x16_bf16 v[104:119], v[84:87], v[16:19], v[104:119]
  ds_read_b64_tr_b16 v[248:249], v22 offset:1280
  ds_read_b64_tr_b16 v[250:251], v22 offset:1344
  ds_read_b64_tr_b16 v[252:253], v22 offset:1408
  ds_read_b64_tr_b16 v[254:255], v22 offset:1472
  v_cvt_pk_bf16_f32 v152, v120, v121
  v_cvt_pk_bf16_f32 v153, v122, v123
  v_cvt_pk_bf16_f32 v154, v124, v125
  v_cvt_pk_bf16_f32 v155, v126, v127
  v_cvt_pk_bf16_f32 v156, v128, v129
  v_cvt_pk_bf16_f32 v157, v130, v131
  v_cvt_pk_bf16_f32 v158, v132, v133
  v_cvt_pk_bf16_f32 v159, v134, v135
  s_waitcnt lgkmcnt(4)
  s_waitcnt lgkmcnt(15)
  v_exp_f32 v136, v136
  v_exp_f32 v137, v137
  v_exp_f32 v138, v138
  v_exp_f32 v139, v139
  v_mfma_f32_32x32x16_bf16 v[168:183], v[240:243], v[152:155], v[168:183]
  v_exp_f32 v140, v140
  v_exp_f32 v141, v141
  v_exp_f32 v142, v142
  v_exp_f32 v143, v143
  v_mfma_f32_32x32x16_bf16 v[120:135], v[88:91], v[12:15], 0
  v_exp_f32 v144, v144
  v_exp_f32 v145, v145
  v_exp_f32 v146, v146
  v_exp_f32 v147, v147
  v_mfma_f32_32x32x16_bf16 v[168:183], v[244:247], v[156:159], v[168:183]
  v_exp_f32 v148, v148
  v_exp_f32 v149, v149
  v_exp_f32 v150, v150
  v_exp_f32 v151, v151
  v_mfma_f32_32x32x16_bf16 v[120:135], v[92:95], v[16:19], v[120:135]
  ds_read_b64_tr_b16 v[240:241], v22 offset:1536
  ds_read_b64_tr_b16 v[242:243], v22 offset:1600
  ds_read_b64_tr_b16 v[244:245], v22 offset:1664
  ds_read_b64_tr_b16 v[246:247], v22 offset:1728
  v_cvt_pk_bf16_f32 v160, v136, v137
  v_cvt_pk_bf16_f32 v161, v138, v139
  v_cvt_pk_bf16_f32 v162, v140, v141
  v_cvt_pk_bf16_f32 v163, v142, v143
  v_cvt_pk_bf16_f32 v164, v144, v145
  v_cvt_pk_bf16_f32 v165, v146, v147
  v_cvt_pk_bf16_f32 v166, v148, v149
  v_cvt_pk_bf16_f32 v167, v150, v151
  s_waitcnt lgkmcnt(4)
  s_waitcnt lgkmcnt(15)
  v_exp_f32 v104, v104
  v_exp_f32 v105, v105
  v_exp_f32 v106, v106
  v_exp_f32 v107, v107
  v_mfma_f32_32x32x16_bf16 v[168:183], v[248:251], v[160:163], v[168:183]
  v_exp_f32 v108, v108
  v_exp_f32 v109, v109
  v_exp_f32 v110, v110
  v_exp_f32 v111, v111
  v_mfma_f32_32x32x16_bf16 v[136:151], v[96:99], v[12:15], v[216:231]
  v_exp_f32 v112, v112
  v_exp_f32 v113, v113
  v_exp_f32 v114, v114
  v_exp_f32 v115, v115
  v_mfma_f32_32x32x16_bf16 v[168:183], v[252:255], v[164:167], v[168:183]
  v_exp_f32 v116, v116
  v_exp_f32 v117, v117
  v_exp_f32 v118, v118
  v_exp_f32 v119, v119
  v_mfma_f32_32x32x16_bf16 v[136:151], v[100:103], v[16:19], v[136:151]
  ds_read_b64_tr_b16 v[248:249], v22 offset:1792
  ds_read_b64_tr_b16 v[250:251], v22 offset:1856
  ds_read_b64_tr_b16 v[252:253], v22 offset:1920
  ds_read_b64_tr_b16 v[254:255], v22 offset:1984
  v_cvt_pk_bf16_f32 v152, v104, v105
  v_cvt_pk_bf16_f32 v153, v106, v107
  v_cvt_pk_bf16_f32 v154, v108, v109
  v_cvt_pk_bf16_f32 v155, v110, v111
  v_cvt_pk_bf16_f32 v156, v112, v113
  v_cvt_pk_bf16_f32 v157, v114, v115
  v_cvt_pk_bf16_f32 v158, v116, v117
  v_cvt_pk_bf16_f32 v159, v118, v119
  ds_read_b64 v[32:33], v20 offset:15520
  ds_read_b64 v[34:35], v20 offset:18624
  ds_read_b64 v[36:37], v21 offset:15520
  ds_read_b64 v[40:41], v20 offset:15776
  ds_read_b64 v[42:43], v20 offset:18880
  ds_read_b64 v[44:45], v21 offset:15776
  ds_read_b64 v[48:49], v20 offset:16032
  ds_read_b64 v[50:51], v20 offset:19136
  ds_read_b64 v[52:53], v21 offset:16032
  ds_read_b64 v[56:57], v20 offset:16288
  ds_read_b64 v[58:59], v20 offset:19392
  ds_read_b64 v[60:61], v21 offset:16288
  ds_read_b64 v[64:65], v20 offset:16544
  ds_read_b64 v[66:67], v20 offset:19648
  ds_read_b64 v[68:69], v21 offset:16544
  s_waitcnt lgkmcnt(15)
  v_exp_f32 v120, v120
  v_exp_f32 v121, v121
  v_exp_f32 v122, v122
  v_exp_f32 v123, v123
  v_mfma_f32_32x32x16_bf16 v[168:183], v[240:243], v[152:155], v[168:183]
  v_exp_f32 v124, v124
  v_exp_f32 v125, v125
  v_exp_f32 v126, v126
  v_exp_f32 v127, v127
  v_mfma_f32_32x32x16_bf16 v[168:183], v[244:247], v[156:159], v[168:183]
  v_exp_f32 v128, v128
  v_exp_f32 v129, v129
  v_exp_f32 v130, v130
  v_exp_f32 v131, v131
  v_exp_f32 v132, v132
  v_exp_f32 v133, v133
  v_exp_f32 v134, v134
  v_exp_f32 v135, v135
  ds_read_b64_tr_b16 v[240:241], v22 offset:2048
  ds_read_b64_tr_b16 v[242:243], v22 offset:2112
  ds_read_b64_tr_b16 v[244:245], v22 offset:2176
  ds_read_b64_tr_b16 v[246:247], v22 offset:2240
  v_cvt_pk_bf16_f32 v160, v120, v121
  v_cvt_pk_bf16_f32 v161, v122, v123
  v_cvt_pk_bf16_f32 v162, v124, v125
  v_cvt_pk_bf16_f32 v163, v126, v127
  v_cvt_pk_bf16_f32 v164, v128, v129
  v_cvt_pk_bf16_f32 v165, v130, v131
  v_cvt_pk_bf16_f32 v166, v132, v133
  v_cvt_pk_bf16_f32 v167, v134, v135
  ds_read_b64 v[72:73], v20 offset:16800
  ds_read_b64 v[74:75], v20 offset:19904
  ds_read_b64 v[76:77], v21 offset:16800
  ds_read_b64 v[80:81], v20 offset:17056
  ds_read_b64 v[82:83], v20 offset:20160
  ds_read_b64 v[84:85], v21 offset:17056
  ds_read_b64 v[88:89], v20 offset:17312
  ds_read_b64 v[90:91], v20 offset:20416
  ds_read_b64 v[92:93], v21 offset:17312
  ds_read_b64 v[96:97], v20 offset:17568
  ds_read_b64 v[98:99], v20 offset:20672
  ds_read_b64 v[100:101], v21 offset:17568
  s_waitcnt lgkmcnt(15)
  v_exp_f32 v136, v136
  v_exp_f32 v137, v137
  v_exp_f32 v138, v138
  v_exp_f32 v139, v139
  v_mfma_f32_32x32x16_bf16 v[168:183], v[248:251], v[160:163], v[168:183]
  v_exp_f32 v140, v140
  v_exp_f32 v141, v141
  v_exp_f32 v142, v142
  v_exp_f32 v143, v143
  v_mfma_f32_32x32x16_bf16 v[168:183], v[252:255], v[164:167], v[168:183]
  v_exp_f32 v144, v144
  v_exp_f32 v145, v145
  v_exp_f32 v146, v146
  v_exp_f32 v147, v147
  v_exp_f32 v148, v148
  v_exp_f32 v149, v149
  v_exp_f32 v150, v150
  v_exp_f32 v151, v151
  v_cvt_pk_bf16_f32 v152, v136, v137
  v_cvt_pk_bf16_f32 v153, v138, v139
  v_cvt_pk_bf16_f32 v154, v140, v141
  v_cvt_pk_bf16_f32 v155, v142, v143
  v_cvt_pk_bf16_f32 v156, v144, v145
  v_cvt_pk_bf16_f32 v157, v146, v147
  v_cvt_pk_bf16_f32 v158, v148, v149
  v_cvt_pk_bf16_f32 v159, v150, v151
  s_waitcnt lgkmcnt(12)
  s_nop 1
  v_mfma_f32_32x32x16_bf16 v[168:183], v[240:243], v[152:155], v[168:183]
  v_mfma_f32_32x32x16_bf16 v[168:183], v[244:247], v[156:159], v[168:183]
  s_add_u32 s41, s40, 0
  v_add_u32 v10, s41, v6
  v_lshrrev_b32 v11, 2, v10
  v_lshlrev_b32 v11, 12, v11
  v_and_b32 v10, 3, v10
  v_lshl_add_u32 v11, v10, 8, v11
  v_add_u32 v11, v11, v24
  s_add_u32 s45, s40, 4
  s_lshr_b32 s44, s45, 2
  s_lshl_b32 s44, s44, 12
  s_and_b32 s45, s45, 3
  s_lshl_b32 s45, s45, 8
  s_add_u32 s44, s44, s45
  s_add_u32 s44, s44, 0
  s_add_u32 s44, s44, s42
  s_nop 1
  v_mov_b32 v30, v176
  v_mov_b32 v31, v176
  s_nop 1
  v_permlane32_swap_b32 v30, v31
  s_nop 1
  v_mov_b32 v29, 0x5d800000
  v_cmp_nle_f32 vcc, v31, v29
  v_mov_b32 v29, 0x21800000
  v_cmp_nge_f32 s[56:57], v31, v29
  s_nop 1
  s_or_b64 vcc, vcc, s[56:57]
  s_mov_b32 s36, 0
  s_cbranch_vccnz L_att_fb
  v_rcp_f32 v31, v31
  s_nop 0
  v_mul_f32 v168, v168, v31
  v_mul_f32 v169, v169, v31
  v_mul_f32 v170, v170, v31
  v_mul_f32 v171, v171, v31
  v_mul_f32 v172, v172, v31
  v_mul_f32 v173, v173, v31
  v_mul_f32 v174, v174, v31
  v_mul_f32 v175, v175, v31
  v_mul_f32 v176, v176, v31
  v_mul_f32 v177, v177, v31
  v_mul_f32 v178, v178, v31
  v_mul_f32 v179, v179, v31
  v_cvt_pk_bf16_f32 v104, v168, v169
  v_cvt_pk_bf16_f32 v105, v170, v171
  v_cvt_pk_bf16_f32 v106, v172, v173
  v_cvt_pk_bf16_f32 v107, v174, v175
  v_cvt_pk_bf16_f32 v108, v176, v177
  v_cvt_pk_bf16_f32 v109, v178, v179
  buffer_store_dwordx4 v[104:107], v11, s[24:27], s42 offen sc1
  s_mov_b32 exec_hi, 0
  buffer_store_dwordx2 v[108:109], v24, s[24:27], s44 offen sc1
  s_mov_b64 exec, -1
  v_mov_b32 v12, v232
  v_mov_b32 v13, v233
  v_mov_b32 v14, v234
  v_mov_b32 v15, v235
  v_mov_b32 v16, v236
  v_mov_b32 v17, v237
  v_mov_b32 v18, v238
  v_mov_b32 v19, v239
  ds_read_b64_tr_b16 v[240:241], v23 offset:0
  ds_read_b64_tr_b16 v[242:243], v23 offset:64
  ds_read_b64_tr_b16 v[244:245], v23 offset:128
  ds_read_b64_tr_b16 v[246:247], v23 offset:192
  s_waitcnt lgkmcnt(15)
  v_mfma_f32_32x32x16_bf16 v[104:119], v[32:35], v[12:15], v[200:215]
  v_mfma_f32_32x32x16_bf16 v[104:119], v[36:39], v[16:19], v[104:119]
  s_waitcnt lgkmcnt(15)
  v_mfma_f32_32x32x16_bf16 v[120:135], v[40:43], v[12:15], 0
  v_mfma_f32_32x32x16_bf16 v[120:135], v[44:47], v[16:19], v[120:135]
  ds_read_b64_tr_b16 v[248:249], v23 offset:256
  ds_read_b64_tr_b16 v[250:251], v23 offset:320
  ds_read_b64_tr_b16 v[252:253], v23 offset:384
  ds_read_b64_tr_b16 v[254:255], v23 offset:448
  s_nop 5
  s_waitcnt lgkmcnt(15)
  v_exp_f32 v104, v104
  v_exp_f32 v105, v105
  v_exp_f32 v106, v106
  v_exp_f32 v107, v107
  v_mfma_f32_32x32x16_bf16 v[136:151], v[48:51], v[12:15], 0
  v_exp_f32 v108, v108
  v_exp_f32 v109, v109
  v_exp_f32 v110, v110
  v_exp_f32 v111, v111
  v_mfma_f32_32x32x16_bf16 v[136:151], v[52:55], v[16:19], v[136:151]
  v_exp_f32 v112, v112
  v_exp_f32 v113, v113
  v_exp_f32 v114, v114
  v_exp_f32 v115, v115
  v_exp_f32 v116, v116
  v_exp_f32 v117, v117
  v_exp_f32 v118, v118
  v_exp_f32 v119, v119
  v_cvt_pk_bf16_f32 v152, v104, v105
  v_cvt_pk_bf16_f32 v153, v106, v107
  v_cvt_pk_bf16_f32 v154, v108, v109
  v_cvt_pk_bf16_f32 v155, v110, v111
  v_cvt_pk_bf16_f32 v156, v112, v113
  v_cvt_pk_bf16_f32 v157, v114, v115
  v_cvt_pk_bf16_f32 v158, v116, v117
  v_cvt_pk_bf16_f32 v159, v118, v119
  s_waitcnt lgkmcnt(4)
  s_waitcnt lgkmcnt(15)
  v_exp_f32 v120, v120
  v_exp_f32 v121, v121
  v_exp_f32 v122, v122
  v_exp_f32 v123, v123
  v_mfma_f32_32x32x16_bf16 v[168:183], v[240:243], v[152:155], 0
  v_exp_f32 v124, v124
  v_exp_f32 v125, v125
  v_exp_f32 v126, v126
  v_exp_f32 v127, v127
  v_mfma_f32_32x32x16_bf16 v[104:119], v[56:59], v[12:15], 0
  v_exp_f32 v128, v128
  v_exp_f32 v129, v129
  v_exp_f32 v130, v130
  v_exp_f32 v131, v131
  v_mfma_f32_32x32x16_bf16 v[168:183], v[244:247], v[156:159], v[168:183]
  v_exp_f32 v132, v132
  v_exp_f32 v133, v133
  v_exp_f32 v134, v134
  v_exp_f32 v135, v135
  v_mfma_f32_32x32x16_bf16 v[104:119], v[60:63], v[16:19], v[104:119]
  ds_read_b64_tr_b16 v[240:241], v23 offset:512
  ds_read_b64_tr_b16 v[242:243], v23 offset:576
  ds_read_b64_tr_b16 v[244:245], v23 offset:640
  ds_read_b64_tr_b16 v[246:247], v23 offset:704
  v_cvt_pk_bf16_f32 v160, v120, v121
  v_cvt_pk_bf16_f32 v161, v122, v123
  v_cvt_pk_bf16_f32 v162, v124, v125
  v_cvt_pk_bf16_f32 v163, v126, v127
  v_cvt_pk_bf16_f32 v164, v128, v129
  v_cvt_pk_bf16_f32 v165, v130, v131
  v_cvt_pk_bf16_f32 v166, v132, v133
  v_cvt_pk_bf16_f32 v167, v134, v135
  s_waitcnt lgkmcnt(4)
  s_waitcnt lgkmcnt(15)
  v_exp_f32 v136, v136
  v_exp_f32 v137, v137
  v_exp_f32 v138, v138
  v_exp_f32 v139, v139
  v_mfma_f32_32x32x16_bf16 v[168:183], v[248:251], v[160:163], v[168:183]
  v_exp_f32 v140, v140
  v_exp_f32 v141, v141
  v_exp_f32 v142, v142
  v_exp_f32 v143, v143
  v_mfma_f32_32x32x16_bf16 v[120:135], v[64:67], v[12:15], 0
  v_exp_f32 v144, v144
  v_exp_f32 v145, v145
  v_exp_f32 v146, v146
  v_exp_f32 v147, v147
  v_mfma_f32_32x32x16_bf16 v[168:183], v[252:255], v[164:167], v[168:183]
  v_exp_f32 v148, v148
  v_exp_f32 v149, v149
  v_exp_f32 v150, v150
  v_exp_f32 v151, v151
  v_mfma_f32_32x32x16_bf16 v[120:135], v[68:71], v[16:19], v[120:135]
  ds_read_b64_tr_b16 v[248:249], v23 offset:768
  ds_read_b64_tr_b16 v[250:251], v23 offset:832
  ds_read_b64_tr_b16 v[252:253], v23 offset:896
  ds_read_b64_tr_b16 v[254:255], v23 offset:960
  v_cvt_pk_bf16_f32 v152, v136, v137
  v_cvt_pk_bf16_f32 v153, v138, v139
  v_cvt_pk_bf16_f32 v154, v140, v141
  v_cvt_pk_bf16_f32 v155, v142, v143
  v_cvt_pk_bf16_f32 v156, v144, v145
  v_cvt_pk_bf16_f32 v157, v146, v147
  v_cvt_pk_bf16_f32 v158, v148, v149
  v_cvt_pk_bf16_f32 v159, v150, v151
  s_waitcnt lgkmcnt(4)
  s_waitcnt lgkmcnt(15)
  v_exp_f32 v104, v104
  v_exp_f32 v105, v105
  v_exp_f32 v106, v106
  v_exp_f32 v107, v107
  v_mfma_f32_32x32x16_bf16 v[168:183], v[240:243], v[152:155], v[168:183]
  v_exp_f32 v108, v108
  v_exp_f32 v109, v109
  v_exp_f32 v110, v110
  v_exp_f32 v111, v111
  v_mfma_f32_32x32x16_bf16 v[136:151], v[72:75], v[12:15], 0
  v_exp_f32 v112, v112
  v_exp_f32 v113, v113
  v_exp_f32 v114, v114
  v_exp_f32 v115, v115
  v_mfma_f32_32x32x16_bf16 v[168:183], v[244:247], v[156:159], v[168:183]
  v_exp_f32 v116, v116
  v_exp_f32 v117, v117
  v_exp_f32 v118, v118
  v_exp_f32 v119, v119
  v_mfma_f32_32x32x16_bf16 v[136:151], v[76:79], v[16:19], v[136:151]
  ds_read_b64_tr_b16 v[240:241], v23 offset:1024
  ds_read_b64_tr_b16 v[242:243], v23 offset:1088
  ds_read_b64_tr_b16 v[244:245], v23 offset:1152
  ds_read_b64_tr_b16 v[246:247], v23 offset:1216
  v_cvt_pk_bf16_f32 v160, v104, v105
  v_cvt_pk_bf16_f32 v161, v106, v107
  v_cvt_pk_bf16_f32 v162, v108, v109
  v_cvt_pk_bf16_f32 v163, v110, v111
  v_cvt_pk_bf16_f32 v164, v112, v113
  v_cvt_pk_bf16_f32 v165, v114, v115
  v_cvt_pk_bf16_f32 v166, v116, v117
  v_cvt_pk_bf16_f32 v167, v118, v119
  s_waitcnt lgkmcnt(4)
  s_waitcnt lgkmcnt(15)
  v_exp_f32 v120, v120
  v_exp_f32 v121, v121
  v_exp_f32 v122, v122
  v_exp_f32 v123, v123
  v_mfma_f32_32x32x16_bf16 v[168:183], v[248:251], v[160:163], v[168:183]
  v_exp_f32 v124, v124
  v_exp_f32 v125, v125
  v_exp_f32 v126, v126
  v_exp_f32 v127, v127
  v_mfma_f32_32x32x16_bf16 v[104:119], v[80:83], v[12:15], 0
  v_exp_f32 v128, v128
  v_exp_f32 v129, v129
  v_exp_f32 v130, v130
  v_exp_f32 v131, v131
  v_mfma_f32_32x32x16_bf16 v[168:183], v[252:255], v[164:167], v[168:183]
  v_exp_f32 v132, v132
  v_exp_f32 v133, v133
  v_exp_f32 v134, v134
  v_exp_f32 v135, v135
  v_mfma_f32_32x32x16_bf16 v[104:119], v[84:87], v[16:19], v[104:119]
  ds_read_b64_tr_b16 v[248:249], v23 offset:1280
  ds_read_b64_tr_b16 v[250:251], v23 offset:1344
  ds_read_b64_tr_b16 v[252:253], v23 offset:1408
  ds_read_b64_tr_b16 v[254:255], v23 offset:1472
  v_cvt_pk_bf16_f32 v152, v120, v121
  v_cvt_pk_bf16_f32 v153, v122, v123
  v_cvt_pk_bf16_f32 v154, v124, v125
  v_cvt_pk_bf16_f32 v155, v126, v127
  v_cvt_pk_bf16_f32 v156, v128, v129
  v_cvt_pk_bf16_f32 v157, v130, v131
  v_cvt_pk_bf16_f32 v158, v132, v133
  v_cvt_pk_bf16_f32 v159, v134, v135
  s_waitcnt lgkmcnt(4)
  s_waitcnt lgkmcnt(15)
  v_exp_f32 v136, v136
  v_exp_f32 v137, v137
  v_exp_f32 v138, v138
  v_exp_f32 v139, v139
  v_mfma_f32_32x32x16_bf16 v[168:183], v[240:243], v[152:155], v[168:183]
  v_exp_f32 v140, v140
  v_exp_f32 v141, v141
  v_exp_f32 v142, v142
  v_exp_f32 v143, v143
  v_mfma_f32_32x32x16_bf16 v[120:135], v[88:91], v[12:15], 0
  v_exp_f32 v144, v144
  v_exp_f32 v145, v145
  v_exp_f32 v146, v146
  v_exp_f32 v147, v147
  v_mfma_f32_32x32x16_bf16 v[168:183], v[244:247], v[156:159], v[168:183]
  v_exp_f32 v148, v148
  v_exp_f32 v149, v149
  v_exp_f32 v150, v150
  v_exp_f32 v151, v151
  v_mfma_f32_32x32x16_bf16 v[120:135], v[92:95], v[16:19], v[120:135]
  ds_read_b64_tr_b16 v[240:241], v23 offset:1536
  ds_read_b64_tr_b16 v[242:243], v23 offset:1600
  ds_read_b64_tr_b16 v[244:245], v23 offset:1664
  ds_read_b64_tr_b16 v[246:247], v23 offset:1728
  v_cvt_pk_bf16_f32 v160, v136, v137
  v_cvt_pk_bf16_f32 v161, v138, v139
  v_cvt_pk_bf16_f32 v162, v140, v141
  v_cvt_pk_bf16_f32 v163, v142, v143
  v_cvt_pk_bf16_f32 v164, v144, v145
  v_cvt_pk_bf16_f32 v165, v146, v147
  v_cvt_pk_bf16_f32 v166, v148, v149
  v_cvt_pk_bf16_f32 v167, v150, v151
  s_waitcnt lgkmcnt(4)
  s_waitcnt lgkmcnt(15)
  v_exp_f32 v104, v104
  v_exp_f32 v105, v105
  v_exp_f32 v106, v106
  v_exp_f32 v107, v107
  v_mfma_f32_32x32x16_bf16 v[168:183], v[248:251], v[160:163], v[168:183]
  v_exp_f32 v108, v108
  v_exp_f32 v109, v109
  v_exp_f32 v110, v110
  v_exp_f32 v111, v111
  v_mfma_f32_32x32x16_bf16 v[136:151], v[96:99], v[12:15], v[216:231]
  v_exp_f32 v112, v112
  v_exp_f32 v113, v113
  v_exp_f32 v114, v114
  v_exp_f32 v115, v115
  v_mfma_f32_32x32x16_bf16 v[168:183], v[252:255], v[164:167], v[168:183]
  v_exp_f32 v116, v116
  v_exp_f32 v117, v117
  v_exp_f32 v118, v118
  v_exp_f32 v119, v119
  v_mfma_f32_32x32x16_bf16 v[136:151], v[100:103], v[16:19], v[136:151]
  ds_read_b64_tr_b16 v[248:249], v23 offset:1792
  ds_read_b64_tr_b16 v[250:251], v23 offset:1856
  ds_read_b64_tr_b16 v[252:253], v23 offset:1920
  ds_read_b64_tr_b16 v[254:255], v23 offset:1984
  v_cvt_pk_bf16_f32 v152, v104, v105
  v_cvt_pk_bf16_f32 v153, v106, v107
  v_cvt_pk_bf16_f32 v154, v108, v109
  v_cvt_pk_bf16_f32 v155, v110, v111
  v_cvt_pk_bf16_f32 v156, v112, v113
  v_cvt_pk_bf16_f32 v157, v114, v115
  v_cvt_pk_bf16_f32 v158, v116, v117
  v_cvt_pk_bf16_f32 v159, v118, v119
  s_waitcnt lgkmcnt(4)
  v_exp_f32 v120, v120
  v_exp_f32 v121, v121
  v_exp_f32 v122, v122
  v_exp_f32 v123, v123
  v_mfma_f32_32x32x16_bf16 v[168:183], v[240:243], v[152:155], v[168:183]
  v_exp_f32 v124, v124
  v_exp_f32 v125, v125
  v_exp_f32 v126, v126
  v_exp_f32 v127, v127
  v_mfma_f32_32x32x16_bf16 v[168:183], v[244:247], v[156:159], v[168:183]
  v_exp_f32 v128, v128
  v_exp_f32 v129, v129
  v_exp_f32 v130, v130
  v_exp_f32 v131, v131
  v_exp_f32 v132, v132
  v_exp_f32 v133, v133
  v_exp_f32 v134, v134
  v_exp_f32 v135, v135
  ds_read_b64_tr_b16 v[240:241], v23 offset:2048
  ds_read_b64_tr_b16 v[242:243], v23 offset:2112
  ds_read_b64_tr_b16 v[244:245], v23 offset:2176
  ds_read_b64_tr_b16 v[246:247], v23 offset:2240
  v_cvt_pk_bf16_f32 v160, v120, v121
  v_cvt_pk_bf16_f32 v161, v122, v123
  v_cvt_pk_bf16_f32 v162, v124, v125
  v_cvt_pk_bf16_f32 v163, v126, v127
  v_cvt_pk_bf16_f32 v164, v128, v129
  v_cvt_pk_bf16_f32 v165, v130, v131
  v_cvt_pk_bf16_f32 v166, v132, v133
  v_cvt_pk_bf16_f32 v167, v134, v135
  s_waitcnt lgkmcnt(4)
  v_exp_f32 v136, v136
  v_exp_f32 v137, v137
  v_exp_f32 v138, v138
  v_exp_f32 v139, v139
  v_mfma_f32_32x32x16_bf16 v[168:183], v[248:251], v[160:163], v[168:183]
  v_exp_f32 v140, v140
  v_exp_f32 v141, v141
  v_exp_f32 v142, v142
  v_exp_f32 v143, v143
  v_mfma_f32_32x32x16_bf16 v[168:183], v[252:255], v[164:167], v[168:183]
  v_exp_f32 v144, v144
  v_exp_f32 v145, v145
  v_exp_f32 v146, v146
  v_exp_f32 v147, v147
  v_exp_f32 v148, v148
  v_exp_f32 v149, v149
  v_exp_f32 v150, v150
  v_exp_f32 v151, v151
  v_cvt_pk_bf16_f32 v152, v136, v137
  v_cvt_pk_bf16_f32 v153, v138, v139
  v_cvt_pk_bf16_f32 v154, v140, v141
  v_cvt_pk_bf16_f32 v155, v142, v143
  v_cvt_pk_bf16_f32 v156, v144, v145
  v_cvt_pk_bf16_f32 v157, v146, v147
  v_cvt_pk_bf16_f32 v158, v148, v149
  v_cvt_pk_bf16_f32 v159, v150, v151
  s_waitcnt lgkmcnt(0)
  s_nop 1
  v_mfma_f32_32x32x16_bf16 v[168:183], v[240:243], v[152:155], v[168:183]
  v_mfma_f32_32x32x16_bf16 v[168:183], v[244:247], v[156:159], v[168:183]
  s_add_u32 s41, s40, 2
  v_add_u32 v10, s41, v6
  v_lshrrev_b32 v11, 2, v10
  v_lshlrev_b32 v11, 12, v11
  v_and_b32 v10, 3, v10
  v_lshl_add_u32 v11, v10, 8, v11
  v_add_u32 v11, v11, v24
  s_add_u32 s45, s40, 4
  s_lshr_b32 s44, s45, 2
  s_lshl_b32 s44, s44, 12
  s_and_b32 s45, s45, 3
  s_lshl_b32 s45, s45, 8
  s_add_u32 s44, s44, s45
  s_add_u32 s44, s44, 8
  s_add_u32 s44, s44, s42
  s_nop 1
  v_mov_b32 v30, v176
  v_mov_b32 v31, v176
  s_nop 1
  v_permlane32_swap_b32 v30, v31
  s_nop 1
  v_mov_b32 v29, 0x5d800000
  v_cmp_nle_f32 vcc, v31, v29
  v_mov_b32 v29, 0x21800000
  v_cmp_nge_f32 s[56:57], v31, v29
  s_nop 1
  s_or_b64 vcc, vcc, s[56:57]
  s_mov_b32 s36, 1
  s_cbranch_vccnz L_att_fb
  v_rcp_f32 v31, v31
  s_nop 0
  v_mul_f32 v168, v168, v31
  v_mul_f32 v169, v169, v31
  v_mul_f32 v170, v170, v31
  v_mul_f32 v171, v171, v31
  v_mul_f32 v172, v172, v31
  v_mul_f32 v173, v173, v31
  v_mul_f32 v174, v174, v31
  v_mul_f32 v175, v175, v31
  v_mul_f32 v176, v176, v31
  v_mul_f32 v177, v177, v31
  v_mul_f32 v178, v178, v31
  v_mul_f32 v179, v179, v31
  v_cvt_pk_bf16_f32 v104, v168, v169
  v_cvt_pk_bf16_f32 v105, v170, v171
  v_cvt_pk_bf16_f32 v106, v172, v173
  v_cvt_pk_bf16_f32 v107, v174, v175
  v_cvt_pk_bf16_f32 v108, v176, v177
  v_cvt_pk_bf16_f32 v109, v178, v179
  buffer_store_dwordx4 v[104:107], v11, s[24:27], s42 offen sc1
  s_mov_b32 exec_hi, 0
  buffer_store_dwordx2 v[108:109], v24, s[24:27], s44 offen sc1
  s_mov_b64 exec, -1
  s_branch L_att_done
L_att_slow:
  s_mov_b32 s36, 0
L_att_fb:
  s_waitcnt lgkmcnt(0)
  v_mov_b32 v18, 0
  v_mov_b32 v238, 0
  s_lshl_b32 s46, s33, 2
  s_add_u32 s46, s46, s35
  s_sub_i32 s46, 8, s46
  s_max_i32 s46, s46, 0
L_att:
  s_mul_i32 s42, s36, 15520
  s_lshl_b32 s43, s35, 8
  s_add_u32 s42, s42, s43
  v_lshlrev_b32 v9, 3, v5
  v_add_u32 v9, s42, v9
  v_mul_u32_u24 v20, 6208, v6
  v_add_u32 v20, v20, v9
  v_add_u32 v21, 12416, v9
  v_bfe_u32 v22, v2, 4, 1
  v_and_b32 v23, 3, v2
  v_bfe_u32 v24, v2, 2, 2
  v_lshl_add_u32 v24, v6, 2, v24
  v_lshlrev_b32 v24, 3, v24
  v_add_u32 v24, s43, v24
  v_lshl_add_u32 v25, v22, 2, v23
  v_mul_u32_u24 v26, 3104, v25
  s_mul_i32 s44, s36, 15520
  s_add_u32 s44, s44, 31040
  v_add_u32 v26, s44, v26
  s_mov_b32 s45, 65408
  s_cmp_eq_u32 s36, 0
  s_cselect_b32 s45, 62176, s45
  v_mov_b32 v27, s45
  v_cmp_lt_u32 vcc, 4, v25
  s_nop 1
  v_cndmask_b32 v26, v26, v27, vcc
  v_add_u32 v22, v26, v24
  v_mov_b32 v182, 0
  v_mov_b32 v183, 0
  v_mov_b32 v190, 0
  v_mov_b32 v191, 0
  v_mov_b32 v28, 0xf149f2ca
  s_cmp_gt_u32 s46, 0
  s_cbranch_scc1 ts_23
  ds_read_b64 v[176:177], v20 offset:0
  ds_read_b64 v[178:179], v20 offset:3104
  ds_read_b64 v[180:181], v21 offset:0
  s_waitcnt lgkmcnt(0)
  v_mfma_f32_32x32x16_bf16 v[32:47], v[176:179], v[12:15], 0
  v_mfma_f32_32x32x16_bf16 v[32:47], v[180:183], v[16:19], v[32:47]
  s_branch td_24
ts_23:
  v_mov_b32 v32, v28
  v_mov_b32 v33, v28
  v_mov_b32 v34, v28
  v_mov_b32 v35, v28
  v_mov_b32 v36, v28
  v_mov_b32 v37, v28
  v_mov_b32 v38, v28
  v_mov_b32 v39, v28
  v_mov_b32 v40, v28
  v_mov_b32 v41, v28
  v_mov_b32 v42, v28
  v_mov_b32 v43, v28
  v_mov_b32 v44, v28
  v_mov_b32 v45, v28
  v_mov_b32 v46, v28
  v_mov_b32 v47, v28
td_24:
  s_cmp_gt_u32 s46, 1
  s_cbranch_scc1 ts_25
  ds_read_b64 v[184:185], v20 offset:256
  ds_read_b64 v[186:187], v20 offset:3360
  ds_read_b64 v[188:189], v21 offset:256
  s_waitcnt lgkmcnt(0)
  v_mfma_f32_32x32x16_bf16 v[48:63], v[184:187], v[12:15], 0
  v_mfma_f32_32x32x16_bf16 v[48:63], v[188:191], v[16:19], v[48:63]
  s_branch td_26
ts_25:
  v_mov_b32 v48, v28
  v_mov_b32 v49, v28
  v_mov_b32 v50, v28
  v_mov_b32 v51, v28
  v_mov_b32 v52, v28
  v_mov_b32 v53, v28
  v_mov_b32 v54, v28
  v_mov_b32 v55, v28
  v_mov_b32 v56, v28
  v_mov_b32 v57, v28
  v_mov_b32 v58, v28
  v_mov_b32 v59, v28
  v_mov_b32 v60, v28
  v_mov_b32 v61, v28
  v_mov_b32 v62, v28
  v_mov_b32 v63, v28
td_26:
  s_cmp_gt_u32 s46, 2
  s_cbranch_scc1 ts_27
  ds_read_b64 v[176:177], v20 offset:512
  ds_read_b64 v[178:179], v20 offset:3616
  ds_read_b64 v[180:181], v21 offset:512
  s_waitcnt lgkmcnt(0)
  v_mfma_f32_32x32x16_bf16 v[64:79], v[176:179], v[12:15], 0
  v_mfma_f32_32x32x16_bf16 v[64:79], v[180:183], v[16:19], v[64:79]
  s_branch td_28
ts_27:
  v_mov_b32 v64, v28
  v_mov_b32 v65, v28
  v_mov_b32 v66, v28
  v_mov_b32 v67, v28
  v_mov_b32 v68, v28
  v_mov_b32 v69, v28
  v_mov_b32 v70, v28
  v_mov_b32 v71, v28
  v_mov_b32 v72, v28
  v_mov_b32 v73, v28
  v_mov_b32 v74, v28
  v_mov_b32 v75, v28
  v_mov_b32 v76, v28
  v_mov_b32 v77, v28
  v_mov_b32 v78, v28
  v_mov_b32 v79, v28
td_28:
  s_cmp_gt_u32 s46, 3
  s_cbranch_scc1 ts_29
  ds_read_b64 v[184:185], v20 offset:768
  ds_read_b64 v[186:187], v20 offset:3872
  ds_read_b64 v[188:189], v21 offset:768
  s_waitcnt lgkmcnt(0)
  v_mfma_f32_32x32x16_bf16 v[80:95], v[184:187], v[12:15], 0
  v_mfma_f32_32x32x16_bf16 v[80:95], v[188:191], v[16:19], v[80:95]
  s_branch td_30
ts_29:
  v_mov_b32 v80, v28
  v_mov_b32 v81, v28
  v_mov_b32 v82, v28
  v_mov_b32 v83, v28
  v_mov_b32 v84, v28
  v_mov_b32 v85, v28
  v_mov_b32 v86, v28
  v_mov_b32 v87, v28
  v_mov_b32 v88, v28
  v_mov_b32 v89, v28
  v_mov_b32 v90, v28
  v_mov_b32 v91, v28
  v_mov_b32 v92, v28
  v_mov_b32 v93, v28
  v_mov_b32 v94, v28
  v_mov_b32 v95, v28
td_30:
  s_cmp_gt_u32 s46, 4
  s_cbranch_scc1 ts_31
  ds_read_b64 v[176:177], v20 offset:1024
  ds_read_b64 v[178:179], v20 offset:4128
  ds_read_b64 v[180:181], v21 offset:1024
  s_waitcnt lgkmcnt(0)
  v_mfma_f32_32x32x16_bf16 v[96:111], v[176:179], v[12:15], 0
  v_mfma_f32_32x32x16_bf16 v[96:111], v[180:183], v[16:19], v[96:111]
  s_branch td_32
ts_31:
  v_mov_b32 v96, v28
  v_mov_b32 v97, v28
  v_mov_b32 v98, v28
  v_mov_b32 v99, v28
  v_mov_b32 v100, v28
  v_mov_b32 v101, v28
  v_mov_b32 v102, v28
  v_mov_b32 v103, v28
  v_mov_b32 v104, v28
  v_mov_b32 v105, v28
  v_mov_b32 v106, v28
  v_mov_b32 v107, v28
  v_mov_b32 v108, v28
  v_mov_b32 v109, v28
  v_mov_b32 v110, v28
  v_mov_b32 v111, v28
td_32:
  s_cmp_gt_u32 s46, 5
  s_cbranch_scc1 ts_33
  ds_read_b64 v[184:185], v20 offset:1280
  ds_read_b64 v[186:187], v20 offset:4384
  ds_read_b64 v[188:189], v21 offset:1280
  s_waitcnt lgkmcnt(0)
  v_mfma_f32_32x32x16_bf16 v[112:127], v[184:187], v[12:15], 0
  v_mfma_f32_32x32x16_bf16 v[112:127], v[188:191], v[16:19], v[112:127]
  s_branch td_34
ts_33:
  v_mov_b32 v112, v28
  v_mov_b32 v113, v28
  v_mov_b32 v114, v28
  v_mov_b32 v115, v28
  v_mov_b32 v116, v28
  v_mov_b32 v117, v28
  v_mov_b32 v118, v28
  v_mov_b32 v119, v28
  v_mov_b32 v120, v28
  v_mov_b32 v121, v28
  v_mov_b32 v122, v28
  v_mov_b32 v123, v28
  v_mov_b32 v124, v28
  v_mov_b32 v125, v28
  v_mov_b32 v126, v28
  v_mov_b32 v127, v28
td_34:
  s_cmp_gt_u32 s46, 6
  s_cbranch_scc1 ts_35
  ds_read_b64 v[176:177], v20 offset:1536
  ds_read_b64 v[178:179], v20 offset:4640
  ds_read_b64 v[180:181], v21 offset:1536
  s_waitcnt lgkmcnt(0)
  v_mfma_f32_32x32x16_bf16 v[128:143], v[176:179], v[12:15], 0
  v_mfma_f32_32x32x16_bf16 v[128:143], v[180:183], v[16:19], v[128:143]
  s_branch td_36
ts_35:
  v_mov_b32 v128, v28
  v_mov_b32 v129, v28
  v_mov_b32 v130, v28
  v_mov_b32 v131, v28
  v_mov_b32 v132, v28
  v_mov_b32 v133, v28
  v_mov_b32 v134, v28
  v_mov_b32 v135, v28
  v_mov_b32 v136, v28
  v_mov_b32 v137, v28
  v_mov_b32 v138, v28
  v_mov_b32 v139, v28
  v_mov_b32 v140, v28
  v_mov_b32 v141, v28
  v_mov_b32 v142, v28
  v_mov_b32 v143, v28
td_36:
  s_cmp_gt_u32 s46, 7
  s_cbranch_scc1 ts_37
  ds_read_b64 v[184:185], v20 offset:1792
  ds_read_b64 v[186:187], v20 offset:4896
  ds_read_b64 v[188:189], v21 offset:1792
  s_waitcnt lgkmcnt(0)
  v_mfma_f32_32x32x16_bf16 v[144:159], v[184:187], v[12:15], 0
  v_mfma_f32_32x32x16_bf16 v[144:159], v[188:191], v[16:19], v[144:159]
  s_branch td_38
ts_37:
  v_mov_b32 v144, v28
  v_mov_b32 v145, v28
  v_mov_b32 v146, v28
  v_mov_b32 v147, v28
  v_mov_b32 v148, v28
  v_mov_b32 v149, v28
  v_mov_b32 v150, v28
  v_mov_b32 v151, v28
  v_mov_b32 v152, v28
  v_mov_b32 v153, v28
  v_mov_b32 v154, v28
  v_mov_b32 v155, v28
  v_mov_b32 v156, v28
  v_mov_b32 v157, v28
  v_mov_b32 v158, v28
  v_mov_b32 v159, v28
td_38:
  s_cmp_gt_u32 s46, 8
  s_cbranch_scc1 ts_39
  ds_read_b64 v[176:177], v20 offset:2048
  ds_read_b64 v[178:179], v20 offset:5152
  ds_read_b64 v[180:181], v21 offset:2048
  s_waitcnt lgkmcnt(0)
  v_mfma_f32_32x32x16_bf16 v[160:175], v[176:179], v[12:15], 0
  v_mfma_f32_32x32x16_bf16 v[160:175], v[180:183], v[16:19], v[160:175]
  s_branch td_40
ts_39:
  v_mov_b32 v160, v28
  v_mov_b32 v161, v28
  v_mov_b32 v162, v28
  v_mov_b32 v163, v28
  v_mov_b32 v164, v28
  v_mov_b32 v165, v28
  v_mov_b32 v166, v28
  v_mov_b32 v167, v28
  v_mov_b32 v168, v28
  v_mov_b32 v169, v28
  v_mov_b32 v170, v28
  v_mov_b32 v171, v28
  v_mov_b32 v172, v28
  v_mov_b32 v173, v28
  v_mov_b32 v174, v28
  v_mov_b32 v175, v28
td_40:
  s_nop 15
  v_lshlrev_b32 v29, 2, v6
  v_sub_u32 v29, v5, v29
  v_cmp_le_i32 vcc, 0, v29
  s_nop 1
  v_cndmask_b32 v160, v28, v160, vcc
  v_cndmask_b32 v32, v32, v28, vcc
  v_cmp_le_i32 vcc, 1, v29
  s_nop 1
  v_cndmask_b32 v161, v28, v161, vcc
  v_cndmask_b32 v33, v33, v28, vcc
  v_cmp_le_i32 vcc, 2, v29
  s_nop 1
  v_cndmask_b32 v162, v28, v162, vcc
  v_cndmask_b32 v34, v34, v28, vcc
  v_cmp_le_i32 vcc, 3, v29
  s_nop 1
  v_cndmask_b32 v163, v28, v163, vcc
  v_cndmask_b32 v35, v35, v28, vcc
  v_cmp_le_i32 vcc, 8, v29
  s_nop 1
  v_cndmask_b32 v164, v28, v164, vcc
  v_cndmask_b32 v36, v36, v28, vcc
  v_cmp_le_i32 vcc, 9, v29
  s_nop 1
  v_cndmask_b32 v165, v28, v165, vcc
  v_cndmask_b32 v37, v37, v28, vcc
  v_cmp_le_i32 vcc, 10, v29
  s_nop 1
  v_cndmask_b32 v166, v28, v166, vcc
  v_cndmask_b32 v38, v38, v28, vcc
  v_cmp_le_i32 vcc, 11, v29
  s_nop 1
  v_cndmask_b32 v167, v28, v167, vcc
  v_cndmask_b32 v39, v39, v28, vcc
  v_cmp_le_i32 vcc, 16, v29
  s_nop 1
  v_cndmask_b32 v168, v28, v168, vcc
  v_cndmask_b32 v40, v40, v28, vcc
  v_cmp_le_i32 vcc, 17, v29
  s_nop 1
  v_cndmask_b32 v169, v28, v169, vcc
  v_cndmask_b32 v41, v41, v28, vcc
  v_cmp_le_i32 vcc, 18, v29
  s_nop 1
  v_cndmask_b32 v170, v28, v170, vcc
  v_cndmask_b32 v42, v42, v28, vcc
  v_cmp_le_i32 vcc, 19, v29
  s_nop 1
  v_cndmask_b32 v171, v28, v171, vcc
  v_cndmask_b32 v43, v43, v28, vcc
  v_cmp_le_i32 vcc, 24, v29
  s_nop 1
  v_cndmask_b32 v172, v28, v172, vcc
  v_cndmask_b32 v44, v44, v28, vcc
  v_cmp_le_i32 vcc, 25, v29
  s_nop 1
  v_cndmask_b32 v173, v28, v173, vcc
  v_cndmask_b32 v45, v45, v28, vcc
  v_cmp_le_i32 vcc, 26, v29
  s_nop 1
  v_cndmask_b32 v174, v28, v174, vcc
  v_cndmask_b32 v46, v46, v28, vcc
  v_cmp_le_i32 vcc, 27, v29
  s_nop 1
  v_cndmask_b32 v175, v28, v175, vcc
  v_cndmask_b32 v47, v47, v28, vcc
  v_max3_f32 v30, v32, v33, v34
  v_max3_f32 v30, v30, v35, v36
  v_max3_f32 v30, v30, v37, v38
  v_max3_f32 v30, v30, v39, v40
  v_max3_f32 v30, v30, v41, v42
  v_max3_f32 v30, v30, v43, v44
  v_max3_f32 v30, v30, v45, v46
  v_max3_f32 v30, v30, v47, v48
  v_max3_f32 v30, v30, v49, v50
  v_max3_f32 v30, v30, v51, v52
  v_max3_f32 v30, v30, v53, v54
  v_max3_f32 v30, v30, v55, v56
  v_max3_f32 v30, v30, v57, v58
  v_max3_f32 v30, v30, v59, v60
  v_max3_f32 v30, v30, v61, v62
  v_max3_f32 v30, v30, v63, v64
  v_max3_f32 v30, v30, v65, v66
  v_max3_f32 v30, v30, v67, v68
  v_max3_f32 v30, v30, v69, v70
  v_max3_f32 v30, v30, v71, v72
  v_max3_f32 v30, v30, v73, v74
  v_max3_f32 v30, v30, v75, v76
  v_max3_f32 v30, v30, v77, v78
  v_max3_f32 v30, v30, v79, v80
  v_max3_f32 v30, v30, v81, v82
  v_max3_f32 v30, v30, v83, v84
  v_max3_f32 v30, v30, v85, v86
  v_max3_f32 v30, v30, v87, v88
  v_max3_f32 v30, v30, v89, v90
  v_max3_f32 v30, v30, v91, v92
  v_max3_f32 v30, v30, v93, v94
  v_max3_f32 v30, v30, v95, v96
  v_max3_f32 v30, v30, v97, v98
  v_max3_f32 v30, v30, v99, v100
  v_max3_f32 v30, v30, v101, v102
  v_max3_f32 v30, v30, v103, v104
  v_max3_f32 v30, v30, v105, v106
  v_max3_f32 v30, v30, v107, v108
  v_max3_f32 v30, v30, v109, v110
  v_max3_f32 v30, v30, v111, v112
  v_max3_f32 v30, v30, v113, v114
  v_max3_f32 v30, v30, v115, v116
  v_max3_f32 v30, v30, v117, v118
  v_max3_f32 v30, v30, v119, v120
  v_max3_f32 v30, v30, v121, v122
  v_max3_f32 v30, v30, v123, v124
  v_max3_f32 v30, v30, v125, v126
  v_max3_f32 v30, v30, v127, v128
  v_max3_f32 v30, v30, v129, v130
  v_max3_f32 v30, v30, v131, v132
  v_max3_f32 v30, v30, v133, v134
  v_max3_f32 v30, v30, v135, v136
  v_max3_f32 v30, v30, v137, v138
  v_max3_f32 v30, v30, v139, v140
  v_max3_f32 v30, v30, v141, v142
  v_max3_f32 v30, v30, v143, v144
  v_max3_f32 v30, v30, v145, v146
  v_max3_f32 v30, v30, v147, v148
  v_max3_f32 v30, v30, v149, v150
  v_max3_f32 v30, v30, v151, v152
  v_max3_f32 v30, v30, v153, v154
  v_max3_f32 v30, v30, v155, v156
  v_max3_f32 v30, v30, v157, v158
  v_max3_f32 v30, v30, v159, v160
  v_max3_f32 v30, v30, v161, v162
  v_max3_f32 v30, v30, v163, v164
  v_max3_f32 v30, v30, v165, v166
  v_max3_f32 v30, v30, v167, v168
  v_max3_f32 v30, v30, v169, v170
  v_max3_f32 v30, v30, v171, v172
  v_max3_f32 v30, v30, v173, v174
  v_max_f32 v30, v30, v175
  v_mov_b32 v31, v30
  v_mov_b32 v29, v30
  s_nop 1
  v_permlane32_swap_b32 v31, v29
  s_nop 1
  v_max_f32 v30, v31, v29
  v_sub_f32 v32, v32, v30
  v_sub_f32 v33, v33, v30
  v_sub_f32 v34, v34, v30
  v_sub_f32 v35, v35, v30
  v_sub_f32 v36, v36, v30
  v_sub_f32 v37, v37, v30
  v_sub_f32 v38, v38, v30
  v_sub_f32 v39, v39, v30
  v_sub_f32 v40, v40, v30
  v_sub_f32 v41, v41, v30
  v_sub_f32 v42, v42, v30
  v_sub_f32 v43, v43, v30
  v_sub_f32 v44, v44, v30
  v_sub_f32 v45, v45, v30
  v_sub_f32 v46, v46, v30
  v_sub_f32 v47, v47, v30
  v_exp_f32 v32, v32
  v_exp_f32 v33, v33
  v_exp_f32 v34, v34
  v_exp_f32 v35, v35
  v_exp_f32 v36, v36
  v_exp_f32 v37, v37
  v_exp_f32 v38, v38
  v_exp_f32 v39, v39
  v_exp_f32 v40, v40
  v_exp_f32 v41, v41
  v_exp_f32 v42, v42
  v_exp_f32 v43, v43
  v_exp_f32 v44, v44
  v_exp_f32 v45, v45
  v_exp_f32 v46, v46
  v_exp_f32 v47, v47
  s_nop 0
  v_cvt_pk_bf16_f32 v32, v32, v33
  v_cvt_pk_bf16_f32 v33, v34, v35
  v_cvt_pk_bf16_f32 v34, v36, v37
  v_cvt_pk_bf16_f32 v35, v38, v39
  v_cvt_pk_bf16_f32 v36, v40, v41
  v_cvt_pk_bf16_f32 v37, v42, v43
  v_cvt_pk_bf16_f32 v38, v44, v45
  v_cvt_pk_bf16_f32 v39, v46, v47
  v_sub_f32 v48, v48, v30
  v_sub_f32 v49, v49, v30
  v_sub_f32 v50, v50, v30
  v_sub_f32 v51, v51, v30
  v_sub_f32 v52, v52, v30
  v_sub_f32 v53, v53, v30
  v_sub_f32 v54, v54, v30
  v_sub_f32 v55, v55, v30
  v_sub_f32 v56, v56, v30
  v_sub_f32 v57, v57, v30
  v_sub_f32 v58, v58, v30
  v_sub_f32 v59, v59, v30
  v_sub_f32 v60, v60, v30
  v_sub_f32 v61, v61, v30
  v_sub_f32 v62, v62, v30
  v_sub_f32 v63, v63, v30
  v_exp_f32 v48, v48
  v_exp_f32 v49, v49
  v_exp_f32 v50, v50
  v_exp_f32 v51, v51
  v_exp_f32 v52, v52
  v_exp_f32 v53, v53
  v_exp_f32 v54, v54
  v_exp_f32 v55, v55
  v_exp_f32 v56, v56
  v_exp_f32 v57, v57
  v_exp_f32 v58, v58
  v_exp_f32 v59, v59
  v_exp_f32 v60, v60
  v_exp_f32 v61, v61
  v_exp_f32 v62, v62
  v_exp_f32 v63, v63
  s_nop 0
  v_cvt_pk_bf16_f32 v48, v48, v49
  v_cvt_pk_bf16_f32 v49, v50, v51
  v_cvt_pk_bf16_f32 v50, v52, v53
  v_cvt_pk_bf16_f32 v51, v54, v55
  v_cvt_pk_bf16_f32 v52, v56, v57
  v_cvt_pk_bf16_f32 v53, v58, v59
  v_cvt_pk_bf16_f32 v54, v60, v61
  v_cvt_pk_bf16_f32 v55, v62, v63
  v_sub_f32 v64, v64, v30
  v_sub_f32 v65, v65, v30
  v_sub_f32 v66, v66, v30
  v_sub_f32 v67, v67, v30
  v_sub_f32 v68, v68, v30
  v_sub_f32 v69, v69, v30
  v_sub_f32 v70, v70, v30
  v_sub_f32 v71, v71, v30
  v_sub_f32 v72, v72, v30
  v_sub_f32 v73, v73, v30
  v_sub_f32 v74, v74, v30
  v_sub_f32 v75, v75, v30
  v_sub_f32 v76, v76, v30
  v_sub_f32 v77, v77, v30
  v_sub_f32 v78, v78, v30
  v_sub_f32 v79, v79, v30
  v_exp_f32 v64, v64
  v_exp_f32 v65, v65
  v_exp_f32 v66, v66
  v_exp_f32 v67, v67
  v_exp_f32 v68, v68
  v_exp_f32 v69, v69
  v_exp_f32 v70, v70
  v_exp_f32 v71, v71
  v_exp_f32 v72, v72
  v_exp_f32 v73, v73
  v_exp_f32 v74, v74
  v_exp_f32 v75, v75
  v_exp_f32 v76, v76
  v_exp_f32 v77, v77
  v_exp_f32 v78, v78
  v_exp_f32 v79, v79
  s_nop 0
  v_cvt_pk_bf16_f32 v64, v64, v65
  v_cvt_pk_bf16_f32 v65, v66, v67
  v_cvt_pk_bf16_f32 v66, v68, v69
  v_cvt_pk_bf16_f32 v67, v70, v71
  v_cvt_pk_bf16_f32 v68, v72, v73
  v_cvt_pk_bf16_f32 v69, v74, v75
  v_cvt_pk_bf16_f32 v70, v76, v77
  v_cvt_pk_bf16_f32 v71, v78, v79
  v_sub_f32 v80, v80, v30
  v_sub_f32 v81, v81, v30
  v_sub_f32 v82, v82, v30
  v_sub_f32 v83, v83, v30
  v_sub_f32 v84, v84, v30
  v_sub_f32 v85, v85, v30
  v_sub_f32 v86, v86, v30
  v_sub_f32 v87, v87, v30
  v_sub_f32 v88, v88, v30
  v_sub_f32 v89, v89, v30
  v_sub_f32 v90, v90, v30
  v_sub_f32 v91, v91, v30
  v_sub_f32 v92, v92, v30
  v_sub_f32 v93, v93, v30
  v_sub_f32 v94, v94, v30
  v_sub_f32 v95, v95, v30
  v_exp_f32 v80, v80
  v_exp_f32 v81, v81
  v_exp_f32 v82, v82
  v_exp_f32 v83, v83
  v_exp_f32 v84, v84
  v_exp_f32 v85, v85
  v_exp_f32 v86, v86
  v_exp_f32 v87, v87
  v_exp_f32 v88, v88
  v_exp_f32 v89, v89
  v_exp_f32 v90, v90
  v_exp_f32 v91, v91
  v_exp_f32 v92, v92
  v_exp_f32 v93, v93
  v_exp_f32 v94, v94
  v_exp_f32 v95, v95
  s_nop 0
  v_cvt_pk_bf16_f32 v80, v80, v81
  v_cvt_pk_bf16_f32 v81, v82, v83
  v_cvt_pk_bf16_f32 v82, v84, v85
  v_cvt_pk_bf16_f32 v83, v86, v87
  v_cvt_pk_bf16_f32 v84, v88, v89
  v_cvt_pk_bf16_f32 v85, v90, v91
  v_cvt_pk_bf16_f32 v86, v92, v93
  v_cvt_pk_bf16_f32 v87, v94, v95
  v_sub_f32 v96, v96, v30
  v_sub_f32 v97, v97, v30
  v_sub_f32 v98, v98, v30
  v_sub_f32 v99, v99, v30
  v_sub_f32 v100, v100, v30
  v_sub_f32 v101, v101, v30
  v_sub_f32 v102, v102, v30
  v_sub_f32 v103, v103, v30
  v_sub_f32 v104, v104, v30
  v_sub_f32 v105, v105, v30
  v_sub_f32 v106, v106, v30
  v_sub_f32 v107, v107, v30
  v_sub_f32 v108, v108, v30
  v_sub_f32 v109, v109, v30
  v_sub_f32 v110, v110, v30
  v_sub_f32 v111, v111, v30
  v_exp_f32 v96, v96
  v_exp_f32 v97, v97
  v_exp_f32 v98, v98
  v_exp_f32 v99, v99
  v_exp_f32 v100, v100
  v_exp_f32 v101, v101
  v_exp_f32 v102, v102
  v_exp_f32 v103, v103
  v_exp_f32 v104, v104
  v_exp_f32 v105, v105
  v_exp_f32 v106, v106
  v_exp_f32 v107, v107
  v_exp_f32 v108, v108
  v_exp_f32 v109, v109
  v_exp_f32 v110, v110
  v_exp_f32 v111, v111
  s_nop 0
  v_cvt_pk_bf16_f32 v96, v96, v97
  v_cvt_pk_bf16_f32 v97, v98, v99
  v_cvt_pk_bf16_f32 v98, v100, v101
  v_cvt_pk_bf16_f32 v99, v102, v103
  v_cvt_pk_bf16_f32 v100, v104, v105
  v_cvt_pk_bf16_f32 v101, v106, v107
  v_cvt_pk_bf16_f32 v102, v108, v109
  v_cvt_pk_bf16_f32 v103, v110, v111
  v_sub_f32 v112, v112, v30
  v_sub_f32 v113, v113, v30
  v_sub_f32 v114, v114, v30
  v_sub_f32 v115, v115, v30
  v_sub_f32 v116, v116, v30
  v_sub_f32 v117, v117, v30
  v_sub_f32 v118, v118, v30
  v_sub_f32 v119, v119, v30
  v_sub_f32 v120, v120, v30
  v_sub_f32 v121, v121, v30
  v_sub_f32 v122, v122, v30
  v_sub_f32 v123, v123, v30
  v_sub_f32 v124, v124, v30
  v_sub_f32 v125, v125, v30
  v_sub_f32 v126, v126, v30
  v_sub_f32 v127, v127, v30
  v_exp_f32 v112, v112
  v_exp_f32 v113, v113
  v_exp_f32 v114, v114
  v_exp_f32 v115, v115
  v_exp_f32 v116, v116
  v_exp_f32 v117, v117
  v_exp_f32 v118, v118
  v_exp_f32 v119, v119
  v_exp_f32 v120, v120
  v_exp_f32 v121, v121
  v_exp_f32 v122, v122
  v_exp_f32 v123, v123
  v_exp_f32 v124, v124
  v_exp_f32 v125, v125
  v_exp_f32 v126, v126
  v_exp_f32 v127, v127
  s_nop 0
  v_cvt_pk_bf16_f32 v112, v112, v113
  v_cvt_pk_bf16_f32 v113, v114, v115
  v_cvt_pk_bf16_f32 v114, v116, v117
  v_cvt_pk_bf16_f32 v115, v118, v119
  v_cvt_pk_bf16_f32 v116, v120, v121
  v_cvt_pk_bf16_f32 v117, v122, v123
  v_cvt_pk_bf16_f32 v118, v124, v125
  v_cvt_pk_bf16_f32 v119, v126, v127
  v_sub_f32 v128, v128, v30
  v_sub_f32 v129, v129, v30
  v_sub_f32 v130, v130, v30
  v_sub_f32 v131, v131, v30
  v_sub_f32 v132, v132, v30
  v_sub_f32 v133, v133, v30
  v_sub_f32 v134, v134, v30
  v_sub_f32 v135, v135, v30
  v_sub_f32 v136, v136, v30
  v_sub_f32 v137, v137, v30
  v_sub_f32 v138, v138, v30
  v_sub_f32 v139, v139, v30
  v_sub_f32 v140, v140, v30
  v_sub_f32 v141, v141, v30
  v_sub_f32 v142, v142, v30
  v_sub_f32 v143, v143, v30
  v_exp_f32 v128, v128
  v_exp_f32 v129, v129
  v_exp_f32 v130, v130
  v_exp_f32 v131, v131
  v_exp_f32 v132, v132
  v_exp_f32 v133, v133
  v_exp_f32 v134, v134
  v_exp_f32 v135, v135
  v_exp_f32 v136, v136
  v_exp_f32 v137, v137
  v_exp_f32 v138, v138
  v_exp_f32 v139, v139
  v_exp_f32 v140, v140
  v_exp_f32 v141, v141
  v_exp_f32 v142, v142
  v_exp_f32 v143, v143
  s_nop 0
  v_cvt_pk_bf16_f32 v128, v128, v129
  v_cvt_pk_bf16_f32 v129, v130, v131
  v_cvt_pk_bf16_f32 v130, v132, v133
  v_cvt_pk_bf16_f32 v131, v134, v135
  v_cvt_pk_bf16_f32 v132, v136, v137
  v_cvt_pk_bf16_f32 v133, v138, v139
  v_cvt_pk_bf16_f32 v134, v140, v141
  v_cvt_pk_bf16_f32 v135, v142, v143
  v_sub_f32 v144, v144, v30
  v_sub_f32 v145, v145, v30
  v_sub_f32 v146, v146, v30
  v_sub_f32 v147, v147, v30
  v_sub_f32 v148, v148, v30
  v_sub_f32 v149, v149, v30
  v_sub_f32 v150, v150, v30
  v_sub_f32 v151, v151, v30
  v_sub_f32 v152, v152, v30
  v_sub_f32 v153, v153, v30
  v_sub_f32 v154, v154, v30
  v_sub_f32 v155, v155, v30
  v_sub_f32 v156, v156, v30
  v_sub_f32 v157, v157, v30
  v_sub_f32 v158, v158, v30
  v_sub_f32 v159, v159, v30
  v_exp_f32 v144, v144
  v_exp_f32 v145, v145
  v_exp_f32 v146, v146
  v_exp_f32 v147, v147
  v_exp_f32 v148, v148
  v_exp_f32 v149, v149
  v_exp_f32 v150, v150
  v_exp_f32 v151, v151
  v_exp_f32 v152, v152
  v_exp_f32 v153, v153
  v_exp_f32 v154, v154
  v_exp_f32 v155, v155
  v_exp_f32 v156, v156
  v_exp_f32 v157, v157
  v_exp_f32 v158, v158
  v_exp_f32 v159, v159
  s_nop 0
  v_cvt_pk_bf16_f32 v144, v144, v145
  v_cvt_pk_bf16_f32 v145, v146, v147
  v_cvt_pk_bf16_f32 v146, v148, v149
  v_cvt_pk_bf16_f32 v147, v150, v151
  v_cvt_pk_bf16_f32 v148, v152, v153
  v_cvt_pk_bf16_f32 v149, v154, v155
  v_cvt_pk_bf16_f32 v150, v156, v157
  v_cvt_pk_bf16_f32 v151, v158, v159
  v_sub_f32 v160, v160, v30
  v_sub_f32 v161, v161, v30
  v_sub_f32 v162, v162, v30
  v_sub_f32 v163, v163, v30
  v_sub_f32 v164, v164, v30
  v_sub_f32 v165, v165, v30
  v_sub_f32 v166, v166, v30
  v_sub_f32 v167, v167, v30
  v_sub_f32 v168, v168, v30
  v_sub_f32 v169, v169, v30
  v_sub_f32 v170, v170, v30
  v_sub_f32 v171, v171, v30
  v_sub_f32 v172, v172, v30
  v_sub_f32 v173, v173, v30
  v_sub_f32 v174, v174, v30
  v_sub_f32 v175, v175, v30
  v_exp_f32 v160, v160
  v_exp_f32 v161, v161
  v_exp_f32 v162, v162
  v_exp_f32 v163, v163
  v_exp_f32 v164, v164
  v_exp_f32 v165, v165
  v_exp_f32 v166, v166
  v_exp_f32 v167, v167
  v_exp_f32 v168, v168
  v_exp_f32 v169, v169
  v_exp_f32 v170, v170
  v_exp_f32 v171, v171
  v_exp_f32 v172, v172
  v_exp_f32 v173, v173
  v_exp_f32 v174, v174
  v_exp_f32 v175, v175
  s_nop 0
  v_cvt_pk_bf16_f32 v160, v160, v161
  v_cvt_pk_bf16_f32 v161, v162, v163
  v_cvt_pk_bf16_f32 v162, v164, v165
  v_cvt_pk_bf16_f32 v163, v166, v167
  v_cvt_pk_bf16_f32 v164, v168, v169
  v_cvt_pk_bf16_f32 v165, v170, v171
  v_cvt_pk_bf16_f32 v166, v172, v173
  v_cvt_pk_bf16_f32 v167, v174, v175
  v_mov_b32 v192, 0
  v_mov_b32 v193, 0
  v_mov_b32 v194, 0
  v_mov_b32 v195, 0
  v_mov_b32 v196, 0
  v_mov_b32 v197, 0
  v_mov_b32 v198, 0
  v_mov_b32 v199, 0
  v_mov_b32 v200, 0
  v_mov_b32 v201, 0
  v_mov_b32 v202, 0
  v_mov_b32 v203, 0
  v_mov_b32 v204, 0
  v_mov_b32 v205, 0
  v_mov_b32 v206, 0
  v_mov_b32 v207, 0
  s_cmp_gt_u32 s46, 0
  s_cbranch_scc1 ps_41
  ds_read_b64_tr_b16 v[208:209], v22 offset:0
  ds_read_b64_tr_b16 v[210:211], v22 offset:64
  ds_read_b64_tr_b16 v[212:213], v22 offset:128
  ds_read_b64_tr_b16 v[214:215], v22 offset:192
  s_waitcnt lgkmcnt(0)
  v_mfma_f32_32x32x16_bf16 v[192:207], v[208:211], v[32:35], v[192:207]
  v_mfma_f32_32x32x16_bf16 v[192:207], v[212:215], v[36:39], v[192:207]
ps_41:
  s_cmp_gt_u32 s46, 1
  s_cbranch_scc1 ps_42
  ds_read_b64_tr_b16 v[216:217], v22 offset:256
  ds_read_b64_tr_b16 v[218:219], v22 offset:320
  ds_read_b64_tr_b16 v[220:221], v22 offset:384
  ds_read_b64_tr_b16 v[222:223], v22 offset:448
  s_waitcnt lgkmcnt(0)
  v_mfma_f32_32x32x16_bf16 v[192:207], v[216:219], v[48:51], v[192:207]
  v_mfma_f32_32x32x16_bf16 v[192:207], v[220:223], v[52:55], v[192:207]
ps_42:
  s_cmp_gt_u32 s46, 2
  s_cbranch_scc1 ps_43
  ds_read_b64_tr_b16 v[208:209], v22 offset:512
  ds_read_b64_tr_b16 v[210:211], v22 offset:576
  ds_read_b64_tr_b16 v[212:213], v22 offset:640
  ds_read_b64_tr_b16 v[214:215], v22 offset:704
  s_waitcnt lgkmcnt(0)
  v_mfma_f32_32x32x16_bf16 v[192:207], v[208:211], v[64:67], v[192:207]
  v_mfma_f32_32x32x16_bf16 v[192:207], v[212:215], v[68:71], v[192:207]
ps_43:
  s_cmp_gt_u32 s46, 3
  s_cbranch_scc1 ps_44
  ds_read_b64_tr_b16 v[216:217], v22 offset:768
  ds_read_b64_tr_b16 v[218:219], v22 offset:832
  ds_read_b64_tr_b16 v[220:221], v22 offset:896
  ds_read_b64_tr_b16 v[222:223], v22 offset:960
  s_waitcnt lgkmcnt(0)
  v_mfma_f32_32x32x16_bf16 v[192:207], v[216:219], v[80:83], v[192:207]
  v_mfma_f32_32x32x16_bf16 v[192:207], v[220:223], v[84:87], v[192:207]
ps_44:
  s_cmp_gt_u32 s46, 4
  s_cbranch_scc1 ps_45
  ds_read_b64_tr_b16 v[208:209], v22 offset:1024
  ds_read_b64_tr_b16 v[210:211], v22 offset:1088
  ds_read_b64_tr_b16 v[212:213], v22 offset:1152
  ds_read_b64_tr_b16 v[214:215], v22 offset:1216
  s_waitcnt lgkmcnt(0)
  v_mfma_f32_32x32x16_bf16 v[192:207], v[208:211], v[96:99], v[192:207]
  v_mfma_f32_32x32x16_bf16 v[192:207], v[212:215], v[100:103], v[192:207]
ps_45:
  s_cmp_gt_u32 s46, 5
  s_cbranch_scc1 ps_46
  ds_read_b64_tr_b16 v[216:217], v22 offset:1280
  ds_read_b64_tr_b16 v[218:219], v22 offset:1344
  ds_read_b64_tr_b16 v[220:221], v22 offset:1408
  ds_read_b64_tr_b16 v[222:223], v22 offset:1472
  s_waitcnt lgkmcnt(0)
  v_mfma_f32_32x32x16_bf16 v[192:207], v[216:219], v[112:115], v[192:207]
  v_mfma_f32_32x32x16_bf16 v[192:207], v[220:223], v[116:119], v[192:207]
ps_46:
  s_cmp_gt_u32 s46, 6
  s_cbranch_scc1 ps_47
  ds_read_b64_tr_b16 v[208:209], v22 offset:1536
  ds_read_b64_tr_b16 v[210:211], v22 offset:1600
  ds_read_b64_tr_b16 v[212:213], v22 offset:1664
  ds_read_b64_tr_b16 v[214:215], v22 offset:1728
  s_waitcnt lgkmcnt(0)
  v_mfma_f32_32x32x16_bf16 v[192:207], v[208:211], v[128:131], v[192:207]
  v_mfma_f32_32x32x16_bf16 v[192:207], v[212:215], v[132:135], v[192:207]
ps_47:
  s_cmp_gt_u32 s46, 7
  s_cbranch_scc1 ps_48
  ds_read_b64_tr_b16 v[216:217], v22 offset:1792
  ds_read_b64_tr_b16 v[218:219], v22 offset:1856
  ds_read_b64_tr_b16 v[220:221], v22 offset:1920
  ds_read_b64_tr_b16 v[222:223], v22 offset:1984
  s_waitcnt lgkmcnt(0)
  v_mfma_f32_32x32x16_bf16 v[192:207], v[216:219], v[144:147], v[192:207]
  v_mfma_f32_32x32x16_bf16 v[192:207], v[220:223], v[148:151], v[192:207]
ps_48:
  s_cmp_gt_u32 s46, 8
  s_cbranch_scc1 ps_49
  ds_read_b64_tr_b16 v[208:209], v22 offset:2048
  ds_read_b64_tr_b16 v[210:211], v22 offset:2112
  ds_read_b64_tr_b16 v[212:213], v22 offset:2176
  ds_read_b64_tr_b16 v[214:215], v22 offset:2240
  s_waitcnt lgkmcnt(0)
  v_mfma_f32_32x32x16_bf16 v[192:207], v[208:211], v[160:163], v[192:207]
  v_mfma_f32_32x32x16_bf16 v[192:207], v[212:215], v[164:167], v[192:207]
ps_49:
  s_nop 7
  s_nop 7
  v_mov_b32 v30, v200
  v_mov_b32 v31, v200
  s_nop 1
  v_permlane32_swap_b32 v30, v31
  s_nop 1
  v_rcp_f32 v31, v31
  s_nop 0
  v_mul_f32 v192, v192, v31
  v_mul_f32 v193, v193, v31
  v_mul_f32 v194, v194, v31
  v_mul_f32 v195, v195, v31
  v_mul_f32 v196, v196, v31
  v_mul_f32 v197, v197, v31
  v_mul_f32 v198, v198, v31
  v_mul_f32 v199, v199, v31
  v_mul_f32 v200, v200, v31
  v_mul_f32 v201, v201, v31
  v_mul_f32 v202, v202, v31
  v_mul_f32 v203, v203, v31
  v_cvt_pk_bf16_f32 v224, v192, v193
  v_cvt_pk_bf16_f32 v225, v194, v195
  v_cvt_pk_bf16_f32 v226, v196, v197
  v_cvt_pk_bf16_f32 v227, v198, v199
  v_cvt_pk_bf16_f32 v228, v200, v201
  v_cvt_pk_bf16_f32 v229, v202, v203
  s_mul_i32 s40, s34, 5
  s_lshl_b32 s41, s36, 1
  s_add_u32 s41, s41, s40
  v_add_u32 v10, s41, v6
  v_lshrrev_b32 v11, 2, v10
  v_lshlrev_b32 v11, 12, v11
  v_and_b32 v10, 3, v10
  v_lshl_add_u32 v11, v10, 8, v11
  v_bfe_u32 v23, v2, 4, 1
  v_lshlrev_b32 v23, 10, v23
  v_and_b32 v24, 15, v2
  v_lshl_add_u32 v23, v24, 4, v23
  v_add_u32 v11, v11, v23
  s_lshl_b32 s42, s33, 1
  s_lshr_b32 s43, s35, 1
  s_add_u32 s42, s42, s43
  s_mul_i32 s42, s42, 68
  s_add_u32 s42, s42, 48
  s_lshl_b32 s42, s42, 12
  s_and_b32 s43, s35, 1
  s_lshl_b32 s43, s43, 11
  s_add_u32 s42, s42, s43
  buffer_store_dwordx4 v[224:227], v11, s[24:27], s42 offen sc1
  s_add_u32 s40, s40, 4
  s_lshr_b32 s44, s40, 2
  s_lshl_b32 s44, s44, 12
  s_and_b32 s45, s40, 3
  s_lshl_b32 s45, s45, 8
  s_add_u32 s44, s44, s45
  s_lshl_b32 s45, s36, 3
  s_add_u32 s44, s44, s45
  s_add_u32 s44, s44, s42
  s_mov_b32 exec_hi, 0
  buffer_store_dwordx2 v[228:229], v23, s[24:27], s44 offen sc1
  s_mov_b64 exec, -1
  s_cmp_eq_u32 s36, 1
  s_cbranch_scc1 L_att_done
  v_mov_b32 v12, v232
  v_mov_b32 v13, v233
  v_mov_b32 v14, v234
  v_mov_b32 v15, v235
  v_mov_b32 v16, v236
  v_mov_b32 v17, v237
  v_mov_b32 v18, v238
  v_mov_b32 v19, v239
  s_mov_b32 s36, 1
  s_branch L_att
L_att_done:
  s_waitcnt vmcnt(0)
  s_lshl_b32 s38, s33, 4
  s_add_u32 s38, s38, s34
  s_lshl_b32 s38, s38, 7
  s_add_u32 s38, s38, 655360
  v_mov_b32 v3, 156716
  v_mov_b32 v4, 1
  s_mov_b64 exec, 1
  ds_add_rtn_u32 v4, v3, v4
  s_waitcnt lgkmcnt(0)
  s_mov_b64 exec, -1
  v_readfirstlane_b32 s37, v4
  s_nop 3
  s_cmp_eq_u32 s37, 3
  s_cbranch_scc0 ag_50
  v_mov_b32 v3, s82
  v_mov_b32 v4, 0
  s_mov_b64 exec, 1
  buffer_store_dword v3, v4, s[16:19], s38 offen sc1
  s_mov_b64 exec, -1
ag_50:
  s_endpgm
L_F:
  s_setprio 2
  s_mov_b32 s45, 0
  s_mov_b32 s46, 0
  s_mul_i32 s40, s33, 163840
  s_lshl_b32 s43, s35, 12
  s_mul_i32 s44, s35, 3072
  v_lshrrev_b32 v3, 3, v2
  s_lshl_b32 s39, s35, 5
  v_add_u32 v3, s39, v3
  v_mul_u32_u24 v3, 1280, v3
  v_and_b32 v4, 7, v2
  v_lshrrev_b32 v5, 4, v2
  v_xor_b32 v6, v4, v5
  v_lshl_add_u32 v10, v6, 4, v3
  v_or_b32 v7, 4, v5
  v_xor_b32 v7, v4, v7
  v_lshl_add_u32 v11, v7, 4, v3
  v_add_u32 v11, 10240, v11
  v_add_u32 v12, 20480, v10
  v_add_u32 v13, 20480, v11
  s_lshl_b32 s39, s35, 4
  v_add_u32 v3, s39, v5
  v_mul_u32_u24 v3, 3840, v3
  v_and_b32 v4, 15, v2
  v_lshlrev_b32 v6, 2, v5
  v_xor_b32 v4, v4, v6
  v_lshl_add_u32 v14, v4, 4, v3
  v_add_u32 v15, 15360, v14
  v_add_u32 v16, 30720, v14
  v_add_u32 v17, 46080, v14
  s_waitcnt lgkmcnt(0)
  s_add_u32 s56, s40, 0
  s_add_u32 s57, s41, 0
  s_add_u32 m0, s43, 0
  s_nop 0
  buffer_load_dwordx4 v10, s[4:7], s56 offen lds
  s_add_u32 m0, s43, 1024
  s_nop 0
  buffer_load_dwordx4 v11, s[4:7], s56 offen lds
  s_add_u32 m0, s43, 2048
  s_nop 0
  buffer_load_dwordx4 v12, s[4:7], s56 offen lds
  s_add_u32 m0, s43, 3072
  s_nop 0
  buffer_load_dwordx4 v13, s[4:7], s56 offen lds
  s_add_u32 m0, s43, 16384
  s_nop 0
  buffer_load_dwordx4 v14, s[8:11], s57 offen lds
  s_add_u32 m0, s43, 17408
  s_nop 0
  buffer_load_dwordx4 v15, s[8:11], s57 offen lds
  s_add_u32 m0, s43, 18432
  s_nop 0
  buffer_load_dwordx4 v16, s[8:11], s57 offen lds
  s_add_u32 m0, s43, 19456
  s_nop 0
  buffer_load_dwordx4 v17, s[8:11], s57 offen lds
  v_lshlrev_b32 v3, 3, v2
  v_mov_b32 v4, 0
  v_mov_b32 v5, 0
  v_add_u32 v6, 156160, v3
  v_add_u32 v3, 156704, v3
  s_mov_b64 exec, 0xff
  ds_write_b64 v3, v[4:5]
  s_mov_b64 exec, -1
  ds_write_b64 v6, v[4:5]
  s_lshl_b32 s39, s35, 4
  v_add_u32 v3, 0, v2
  v_mul_u32_u24 v4, 171, v3
  v_lshrrev_b32 v4, 11, v4
  v_mul_u32_u24 v5, 12, v4
  v_sub_u32 v5, v3, v5
  v_add_u32 v4, s39, v4
  v_mul_u32_u24 v4, 3072, v4
  v_lshl_add_u32 v34, v5, 4, v4
  v_add_u32 v3, 64, v2
  v_mul_u32_u24 v4, 171, v3
  v_lshrrev_b32 v4, 11, v4
  v_mul_u32_u24 v5, 12, v4
  v_sub_u32 v5, v3, v5
  v_add_u32 v4, s39, v4
  v_mul_u32_u24 v4, 3072, v4
  v_lshl_add_u32 v35, v5, 4, v4
  v_add_u32 v3, 128, v2
  v_mul_u32_u24 v4, 171, v3
  v_lshrrev_b32 v4, 11, v4
  v_mul_u32_u24 v5, 12, v4
  v_sub_u32 v5, v3, v5
  v_add_u32 v4, s39, v4
  v_mul_u32_u24 v4, 3072, v4
  v_lshl_add_u32 v40, v5, 4, v4
  v_and_b32 v3, 31, v2
  s_lshl_b32 s37, s35, 5
  v_add_u32 v3, s37, v3
  v_lshrrev_b32 v4, 5, v2
  v_bfe_u32 v5, v3, 1, 3
  v_xor_b32 v5, v5, v4
  v_lshlrev_b32 v3, 7, v3
  v_xor_b32 v6, 0, v5
  v_lshl_add_u32 v18, v6, 4, v3
  v_add_u32 v22, 65536, v18
  v_xor_b32 v6, 2, v5
  v_lshl_add_u32 v19, v6, 4, v3
  v_add_u32 v23, 65536, v19
  v_xor_b32 v6, 4, v5
  v_lshl_add_u32 v20, v6, 4, v3
  v_add_u32 v24, 65536, v20
  v_xor_b32 v6, 6, v5
  v_lshl_add_u32 v21, v6, 4, v3
  v_add_u32 v25, 65536, v21
  v_bfe_u32 v3, v2, 4, 1
  v_lshrrev_b32 v4, 5, v2
  v_bfe_u32 v5, v2, 2, 2
  v_and_b32 v6, 3, v2
  v_lshl_add_u32 v7, v4, 3, v5
  v_mul_u32_u24 v41, 192, v7
  v_lshl_add_u32 v41, v3, 5, v41
  v_lshl_add_u32 v41, v6, 3, v41
  v_add_u32 v47, 131072, v41
  v_add_u32 v46, 69632, v41
  v_lshlrev_b32 v8, 8, v7
  v_add_u32 v8, 16384, v8
  v_lshrrev_b32 v9, 1, v6
  v_lshl_add_u32 v9, v3, 1, v9
  v_lshl_add_u32 v8, v9, 4, v8
  v_and_b32 v9, 1, v6
  v_lshl_add_u32 v8, v9, 3, v8
  v_xor_b32 v9, s35, v5
  v_lshl_add_u32 v64, v9, 6, v8
  v_add_u32 v65, 65536, v64
  v_and_b32 v3, 15, v2
  v_bfe_u32 v4, v2, 4, 1
  v_cmp_eq_u32 vcc, v3, v4
  v_mov_b32 v5, 0x3f803f80
  s_nop 0
  v_cndmask_b32 v36, 0, v5, vcc
  v_mov_b32 v37, v36
  v_mov_b32 v38, v36
  v_mov_b32 v39, v36
  v_mov_b32 v66, 0
  v_mov_b32 v67, 0
  v_mov_b32 v68, 0
  v_mov_b32 v69, 0
  s_add_u32 s56, s40, 128
  s_add_u32 s57, s41, 245760
  s_add_u32 m0, s43, 32768
  s_nop 0
  buffer_load_dwordx4 v10, s[4:7], s56 offen lds
  s_add_u32 m0, s43, 33792
  s_nop 0
  buffer_load_dwordx4 v11, s[4:7], s56 offen lds
  s_add_u32 m0, s43, 34816
  s_nop 0
  buffer_load_dwordx4 v12, s[4:7], s56 offen lds
  s_add_u32 m0, s43, 35840
  s_nop 0
  buffer_load_dwordx4 v13, s[4:7], s56 offen lds
  s_add_u32 m0, s43, 49152
  s_nop 0
  buffer_load_dwordx4 v14, s[8:11], s57 offen lds
  s_add_u32 m0, s43, 50176
  s_nop 0
  buffer_load_dwordx4 v15, s[8:11], s57 offen lds
  s_add_u32 m0, s43, 51200
  s_nop 0
  buffer_load_dwordx4 v16, s[8:11], s57 offen lds
  s_add_u32 m0, s43, 52224
  s_nop 0
  buffer_load_dwordx4 v17, s[8:11], s57 offen lds
  s_add_u32 s56, s40, 256
  s_add_u32 s57, s41, 491520
  s_add_u32 m0, s43, 65536
  s_nop 0
  buffer_load_dwordx4 v10, s[4:7], s56 offen lds
  s_add_u32 m0, s43, 66560
  s_nop 0
  buffer_load_dwordx4 v11, s[4:7], s56 offen lds
  s_add_u32 m0, s43, 67584
  s_nop 0
  buffer_load_dwordx4 v12, s[4:7], s56 offen lds
  s_add_u32 m0, s43, 68608
  s_nop 0
  buffer_load_dwordx4 v13, s[4:7], s56 offen lds
  s_add_u32 m0, s43, 81920
  s_nop 0
  buffer_load_dwordx4 v14, s[8:11], s57 offen lds
  s_add_u32 m0, s43, 82944
  s_nop 0
  buffer_load_dwordx4 v15, s[8:11], s57 offen lds
  s_add_u32 m0, s43, 83968
  s_nop 0
  buffer_load_dwordx4 v16, s[8:11], s57 offen lds
  s_add_u32 m0, s43, 84992
  s_nop 0
  buffer_load_dwordx4 v17, s[8:11], s57 offen lds
  s_waitcnt vmcnt(16)
  s_waitcnt lgkmcnt(0)
  s_barrier
  s_lshl_b32 s37, s33, 7
  s_lshl_b32 s38, s34, 3
  s_add_u32 s37, s37, s38
  s_lshl_b32 s38, s35, 1
  s_add_u32 s37, s37, s38
  s_mul_i32 s36, s37, 1280
  v_and_b32 v3, 31, v2
  v_mul_u32_u24 v3, 40, v3
  v_lshrrev_b32 v4, 5, v2
  v_mul_u32_u24 v4, 1280, v4
  v_add_u32 v3, v3, v4
  s_mov_b32 s48, s78
  s_mov_b32 s49, s79
  s_mov_b32 s50, 256
  s_mov_b32 s51, 0x20000
  s_or_b32 s37, s2, s35
  s_cmp_eq_u32 s37, 0
  s_cbranch_scc0 non_51
  s_memrealtime s[54:55]
  s_waitcnt lgkmcnt(0)
  s_or_b32 s54, s54, 1
  v_mov_b32 v6, s54
  v_mov_b32 v7, 0
  s_mov_b64 exec, 1
  buffer_store_dword v6, v7, s[48:51], 0 offen sc1
  s_mov_b64 exec, -1
non_51:
  v_mov_b32 v82, 0
  v_mov_b32 v81, 0
  s_cmp_eq_u32 s35, 0
  s_cbranch_scc0 nl_52
  buffer_load_dword v81, v82, s[48:51], 0 offen sc1
nl_52:
  buffer_load_dwordx4 v[70:73], v3, s[4:7], s36 offen
  buffer_load_dwordx4 v[74:77], v3, s[4:7], s36 offen offset:16
  buffer_load_dwordx2 v[78:79], v3, s[4:7], s36 offen offset:32
  s_mov_b32 s52, s70
  s_mov_b32 s53, s71
  s_mov_b32 s54, 3072
  s_mov_b32 s55, 0x20000
  v_lshlrev_b32 v4, 2, v2
  s_mul_i32 s37, s34, 192
  v_min_u32 v4, 188, v4
  buffer_load_dword v80, v4, s[52:55], s37 offen
  ds_read_b128 v[96:99], v18 offset:0
  ds_read_b128 v[100:103], v19 offset:0
  ds_read_b128 v[104:107], v20 offset:0
  ds_read_b128 v[108:111], v21 offset:0
  ds_read_b64_tr_b16 v[48:49], v64 offset:0
  ds_read_b64_tr_b16 v[50:51], v64 offset:1024
  ds_read_b64_tr_b16 v[52:53], v64 offset:4096
  ds_read_b64_tr_b16 v[54:55], v64 offset:5120
  ds_read_b64_tr_b16 v[56:57], v64 offset:8192
  ds_read_b64_tr_b16 v[58:59], v64 offset:9216
  ds_read_b64_tr_b16 v[60:61], v64 offset:12288
  ds_read_b64_tr_b16 v[62:63], v64 offset:13312
  s_add_u32 s56, s40, 384
  s_add_u32 s57, s41, 737280
  s_add_u32 m0, s43, 98304
  s_nop 0
  buffer_load_dwordx4 v10, s[4:7], s56 offen lds
  s_add_u32 m0, s43, 99328
  s_nop 0
  buffer_load_dwordx4 v11, s[4:7], s56 offen lds
  s_waitcnt lgkmcnt(6)
  v_mfma_f32_16x16x32_bf16 v[66:69], v[36:39], v[48:51], v[66:69]
  s_waitcnt lgkmcnt(4)
  v_mfma_f32_16x16x32_bf16 v[66:69], v[36:39], v[52:55], v[66:69]
  s_waitcnt lgkmcnt(2)
  v_mfma_f32_16x16x32_bf16 v[66:69], v[36:39], v[56:59], v[66:69]
  s_waitcnt lgkmcnt(0)
  v_mfma_f32_16x16x32_bf16 v[66:69], v[36:39], v[60:63], v[66:69]
  s_add_u32 m0, s43, 100352
  s_nop 0
  buffer_load_dwordx4 v12, s[4:7], s56 offen lds
  s_add_u32 m0, s43, 101376
  s_nop 0
  buffer_load_dwordx4 v13, s[4:7], s56 offen lds
  s_add_u32 m0, s43, 114688
  s_nop 0
  buffer_load_dwordx4 v14, s[8:11], s57 offen lds
  s_add_u32 m0, s43, 115712
  s_nop 0
  buffer_load_dwordx4 v15, s[8:11], s57 offen lds
  s_add_u32 m0, s43, 116736
  s_nop 0
  buffer_load_dwordx4 v16, s[8:11], s57 offen lds
  s_add_u32 m0, s43, 117760
  s_nop 0
  buffer_load_dwordx4 v17, s[8:11], s57 offen lds
  s_waitcnt vmcnt(20)
  s_waitcnt lgkmcnt(0)
  s_barrier
  ds_read_b128 v[112:115], v18 offset:32768
  ds_read_b128 v[116:119], v19 offset:32768
  ds_read_b128 v[120:123], v20 offset:32768
  ds_read_b128 v[124:127], v21 offset:32768
  ds_read_b64_tr_b16 v[48:49], v64 offset:32768
  ds_read_b64_tr_b16 v[50:51], v64 offset:33792
  ds_read_b64_tr_b16 v[52:53], v64 offset:36864
  ds_read_b64_tr_b16 v[54:55], v64 offset:37888
  ds_read_b64_tr_b16 v[56:57], v64 offset:40960
  ds_read_b64_tr_b16 v[58:59], v64 offset:41984
  ds_read_b64_tr_b16 v[60:61], v64 offset:45056
  ds_read_b64_tr_b16 v[62:63], v64 offset:46080
  s_waitcnt vmcnt(8)
  s_cmp_eq_u32 s35, 0
  s_cbranch_scc0 n2_55
  s_mov_b32 s37, 0
n0_53:
  v_readfirstlane_b32 s82, v81
  s_nop 3
  s_cmp_lg_u32 s82, 0
  s_cbranch_scc1 n1_54
  s_add_u32 s37, s37, 1
  s_cmp_lt_u32 s37, 20000
  s_cbranch_scc0 n1_54
  s_sleep 1
  buffer_load_dword v81, v82, s[48:51], 0 offen sc1
  s_waitcnt vmcnt(0)
  s_branch n0_53
n1_54:
  v_mov_b32 v82, 156672
  ds_write_b32 v82, v81
n2_55:
  s_waitcnt lgkmcnt(6)
  v_mfma_f32_16x16x32_bf16 v[66:69], v[36:39], v[48:51], v[66:69]
  s_waitcnt lgkmcnt(4)
  v_mfma_f32_16x16x32_bf16 v[66:69], v[36:39], v[52:55], v[66:69]
  s_waitcnt lgkmcnt(2)
  v_mfma_f32_16x16x32_bf16 v[66:69], v[36:39], v[56:59], v[66:69]
  s_waitcnt lgkmcnt(0)
  v_mfma_f32_16x16x32_bf16 v[66:69], v[36:39], v[60:63], v[66:69]
  v_lshlrev_b32 v82, 16, v80
  v_and_b32 v83, 0xffff0000, v80
  v_min_u32 v4, 47, v2
  v_lshlrev_b32 v4, 3, v4
  v_add_u32 v4, 156928, v4
  ds_write_b64 v4, v[82:83]
  v_lshlrev_b32 v200, 16, v70
  v_and_b32 v201, 0xffff0000, v70
  v_lshlrev_b32 v202, 16, v71
  v_and_b32 v203, 0xffff0000, v71
  v_lshlrev_b32 v204, 16, v72
  v_and_b32 v205, 0xffff0000, v72
  v_lshlrev_b32 v206, 16, v73
  v_and_b32 v207, 0xffff0000, v73
  v_lshlrev_b32 v208, 16, v74
  v_and_b32 v209, 0xffff0000, v74
  v_lshlrev_b32 v210, 16, v75
  v_and_b32 v211, 0xffff0000, v75
  v_lshlrev_b32 v212, 16, v76
  v_and_b32 v213, 0xffff0000, v76
  v_lshlrev_b32 v214, 16, v77
  v_and_b32 v215, 0xffff0000, v77
  v_lshlrev_b32 v216, 16, v78
  v_and_b32 v217, 0xffff0000, v78
  v_lshlrev_b32 v218, 16, v79
  v_and_b32 v219, 0xffff0000, v79
  v_add_f32 v70, v200, v201
  v_add_f32 v71, v202, v203
  v_add_f32 v70, v70, v204
  v_add_f32 v71, v71, v205
  v_add_f32 v70, v70, v206
  v_add_f32 v71, v71, v207
  v_add_f32 v70, v70, v208
  v_add_f32 v71, v71, v209
  v_add_f32 v70, v70, v210
  v_add_f32 v71, v71, v211
  v_add_f32 v70, v70, v212
  v_add_f32 v71, v71, v213
  v_add_f32 v70, v70, v214
  v_add_f32 v71, v71, v215
  v_add_f32 v70, v70, v216
  v_add_f32 v71, v71, v217
  v_add_f32 v70, v70, v218
  v_add_f32 v71, v71, v219
  v_add_f32 v70, v70, v71
  s_nop 1
  v_add_f32_dpp v70, v70, v70 quad_perm:[1,0,3,2] row_mask:0xf bank_mask:0xf
  s_nop 1
  v_add_f32_dpp v70, v70, v70 quad_perm:[2,3,0,1] row_mask:0xf bank_mask:0xf
  s_nop 1
  v_add_f32_dpp v70, v70, v70 row_half_mirror row_mask:0xf bank_mask:0xf
  s_nop 1
  v_add_f32_dpp v70, v70, v70 row_mirror row_mask:0xf bank_mask:0xf
  v_mov_b32 v78, v70
  v_mov_b32 v79, v70
  s_nop 1
  v_permlane16_swap_b32 v78, v79
  s_nop 1
  v_add_f32 v70, v78, v79
  v_mul_f32 v70, 0x3acccccd, v70
  s_waitcnt vmcnt(12)
  s_waitcnt lgkmcnt(0)
  s_barrier
  ds_read_b128 v[128:131], v22 offset:0
  ds_read_b128 v[132:135], v23 offset:0
  ds_read_b128 v[136:139], v24 offset:0
  ds_read_b128 v[140:143], v25 offset:0
  ds_read_b64_tr_b16 v[48:49], v65 offset:0
  ds_read_b64_tr_b16 v[50:51], v65 offset:1024
  ds_read_b64_tr_b16 v[52:53], v65 offset:4096
  ds_read_b64_tr_b16 v[54:55], v65 offset:5120
  ds_read_b64_tr_b16 v[56:57], v65 offset:8192
  ds_read_b64_tr_b16 v[58:59], v65 offset:9216
  ds_read_b64_tr_b16 v[60:61], v65 offset:12288
  ds_read_b64_tr_b16 v[62:63], v65 offset:13312
  v_sub_f32 v200, v200, v70
  v_sub_f32 v201, v201, v70
  v_sub_f32 v202, v202, v70
  v_sub_f32 v203, v203, v70
  v_sub_f32 v204, v204, v70
  v_sub_f32 v205, v205, v70
  v_sub_f32 v206, v206, v70
  v_sub_f32 v207, v207, v70
  v_sub_f32 v208, v208, v70
  v_sub_f32 v209, v209, v70
  s_add_u32 s56, s40, 512
  s_add_u32 s57, s41, 983040
  s_add_u32 m0, s43, 0
  s_nop 0
  buffer_load_dwordx4 v10, s[4:7], s56 offen lds
  v_sub_f32 v210, v210, v70
  v_sub_f32 v211, v211, v70
  v_sub_f32 v212, v212, v70
  v_sub_f32 v213, v213, v70
  v_sub_f32 v214, v214, v70
  v_sub_f32 v215, v215, v70
  v_sub_f32 v216, v216, v70
  v_sub_f32 v217, v217, v70
  v_sub_f32 v218, v218, v70
  v_sub_f32 v219, v219, v70
  s_add_u32 m0, s43, 1024
  s_nop 0
  buffer_load_dwordx4 v11, s[4:7], s56 offen lds
  v_mul_f32 v71, v200, v200
  v_mul_f32 v72, v201, v201
  v_fmac_f32 v71, v202, v202
  v_fmac_f32 v72, v203, v203
  v_fmac_f32 v71, v204, v204
  v_fmac_f32 v72, v205, v205
  v_fmac_f32 v71, v206, v206
  v_fmac_f32 v72, v207, v207
  v_fmac_f32 v71, v208, v208
  v_fmac_f32 v72, v209, v209
  s_waitcnt lgkmcnt(6)
  v_mfma_f32_16x16x32_bf16 v[66:69], v[36:39], v[48:51], v[66:69]
  s_waitcnt lgkmcnt(4)
  v_mfma_f32_16x16x32_bf16 v[66:69], v[36:39], v[52:55], v[66:69]
  s_waitcnt lgkmcnt(2)
  v_mfma_f32_16x16x32_bf16 v[66:69], v[36:39], v[56:59], v[66:69]
  s_waitcnt lgkmcnt(0)
  v_mfma_f32_16x16x32_bf16 v[66:69], v[36:39], v[60:63], v[66:69]
  s_add_u32 m0, s43, 2048
  s_nop 0
  buffer_load_dwordx4 v12, s[4:7], s56 offen lds
  v_fmac_f32 v71, v210, v210
  v_fmac_f32 v72, v211, v211
  v_fmac_f32 v71, v212, v212
  v_fmac_f32 v72, v213, v213
  v_fmac_f32 v71, v214, v214
  v_fmac_f32 v72, v215, v215
  v_fmac_f32 v71, v216, v216
  v_fmac_f32 v72, v217, v217
  v_fmac_f32 v71, v218, v218
  v_fmac_f32 v72, v219, v219
  s_add_u32 m0, s43, 3072
  s_nop 0
  buffer_load_dwordx4 v13, s[4:7], s56 offen lds
  v_add_f32 v71, v71, v72
  s_nop 1
  v_add_f32_dpp v71, v71, v71 quad_perm:[1,0,3,2] row_mask:0xf bank_mask:0xf
  s_nop 1
  v_add_f32_dpp v71, v71, v71 quad_perm:[2,3,0,1] row_mask:0xf bank_mask:0xf
  s_nop 1
  v_add_f32_dpp v71, v71, v71 row_half_mirror row_mask:0xf bank_mask:0xf
  s_nop 1
  v_add_f32_dpp v71, v71, v71 row_mirror row_mask:0xf bank_mask:0xf
  v_mov_b32 v78, v71
  v_mov_b32 v79, v71
  s_add_u32 m0, s43, 16384
  s_nop 0
  buffer_load_dwordx4 v14, s[8:11], s57 offen lds
  s_nop 1
  v_permlane16_swap_b32 v78, v79
  s_nop 1
  v_add_f32 v71, v78, v79
  v_mul_f32 v71, 0x3acccccd, v71
  v_add_f32 v72, 0x3727c5ac, v71
  v_rsq_f32 v75, v72
  s_nop 0
  v_mul_f32 v73, v75, v75
  v_mul_f32 v73, v73, v71
  s_add_u32 m0, s43, 17408
  s_nop 0
  buffer_load_dwordx4 v15, s[8:11], s57 offen lds
  v_add_f32 v73, 0x3727c5ac, v73
  v_rsq_f32 v73, v73
  v_mov_b32 v74, v70
  s_nop 0
  v_mul_f32 v76, v75, v73
  v_lshrrev_b32 v78, 5, v2
  v_lshlrev_b32 v78, 4, v78
  s_lshl_b32 s37, s35, 5
  s_add_u32 s37, s37, 156768
  v_add_u32 v78, s37, v78
  s_add_u32 m0, s43, 18432
  s_nop 0
  buffer_load_dwordx4 v16, s[8:11], s57 offen lds
  v_mov_b32 v77, 0
  ds_write_b128 v78, v[74:77]
  s_add_u32 m0, s43, 19456
  s_nop 0
  buffer_load_dwordx4 v17, s[8:11], s57 offen lds
  s_waitcnt vmcnt(8)
  s_waitcnt lgkmcnt(0)
  s_barrier
  ds_read_b128 v[144:147], v22 offset:32768
  ds_read_b128 v[148:151], v23 offset:32768
  ds_read_b128 v[152:155], v24 offset:32768
  ds_read_b128 v[156:159], v25 offset:32768
  ds_read_b64_tr_b16 v[48:49], v65 offset:32768
  ds_read_b64_tr_b16 v[50:51], v65 offset:33792
  ds_read_b64_tr_b16 v[52:53], v65 offset:36864
  ds_read_b64_tr_b16 v[54:55], v65 offset:37888
  ds_read_b64_tr_b16 v[56:57], v65 offset:40960
  ds_read_b64_tr_b16 v[58:59], v65 offset:41984
  ds_read_b64_tr_b16 v[60:61], v65 offset:45056
  ds_read_b64_tr_b16 v[62:63], v65 offset:46080
  v_mov_b32 v3, 156672
  ds_read_b32 v83, v3
  v_and_b32 v78, 7, v2
  v_lshlrev_b32 v78, 4, v78
  v_add_u32 v79, 156768, v78
  ds_read_b128 v[74:77], v79
  s_waitcnt lgkmcnt(0)
  v_mov_b32 v77, v83
  v_readfirstlane_b32 s82, v83
  s_cmp_eq_u32 s35, 0
  s_cbranch_scc0 sst_56
  s_lshl_b32 s37, s33, 7
  s_lshl_b32 s38, s34, 3
  s_add_u32 s37, s37, s38
  s_lshl_b32 s37, s37, 4
  s_mov_b64 exec, 0xff
  buffer_store_dwordx4 v[74:77], v78, s[16:19], s37 offen sc1
  s_mov_b64 exec, -1
sst_56:
  s_add_u32 s56, s40, 640
  s_add_u32 s57, s41, 1228800
  s_add_u32 m0, s43, 32768
  s_nop 0
  buffer_load_dwordx4 v10, s[4:7], s56 offen lds
  s_add_u32 m0, s43, 33792
  s_nop 0
  buffer_load_dwordx4 v11, s[4:7], s56 offen lds
  s_waitcnt lgkmcnt(8)
  v_mfma_f32_16x16x32_bf16 v[66:69], v[36:39], v[48:51], v[66:69]
  s_waitcnt lgkmcnt(6)
  v_mfma_f32_16x16x32_bf16 v[66:69], v[36:39], v[52:55], v[66:69]
  s_waitcnt lgkmcnt(4)
  v_mfma_f32_16x16x32_bf16 v[66:69], v[36:39], v[56:59], v[66:69]
  s_waitcnt lgkmcnt(2)
  v_mfma_f32_16x16x32_bf16 v[66:69], v[36:39], v[60:63], v[66:69]
  s_add_u32 m0, s43, 34816
  s_nop 0
  buffer_load_dwordx4 v12, s[4:7], s56 offen lds
  s_add_u32 m0, s43, 35840
  s_nop 0
  buffer_load_dwordx4 v13, s[4:7], s56 offen lds
  s_add_u32 m0, s43, 49152
  s_nop 0
  buffer_load_dwordx4 v14, s[8:11], s57 offen lds
  s_add_u32 m0, s43, 50176
  s_nop 0
  buffer_load_dwordx4 v15, s[8:11], s57 offen lds
  s_add_u32 m0, s43, 51200
  s_nop 0
  buffer_load_dwordx4 v16, s[8:11], s57 offen lds
  s_add_u32 m0, s43, 52224
  s_nop 0
  buffer_load_dwordx4 v17, s[8:11], s57 offen lds
  s_waitcnt vmcnt(8)
  s_waitcnt lgkmcnt(0)
  s_barrier
  ds_read_b128 v[160:163], v18 offset:0
  ds_read_b128 v[164:167], v19 offset:0
  ds_read_b128 v[168:171], v20 offset:0
  ds_read_b128 v[172:175], v21 offset:0
  ds_read_b64_tr_b16 v[48:49], v64 offset:0
  ds_read_b64_tr_b16 v[50:51], v64 offset:1024
  ds_read_b64_tr_b16 v[52:53], v64 offset:4096
  ds_read_b64_tr_b16 v[54:55], v64 offset:5120
  ds_read_b64_tr_b16 v[56:57], v64 offset:8192
  ds_read_b64_tr_b16 v[58:59], v64 offset:9216
  ds_read_b64_tr_b16 v[60:61], v64 offset:12288
  ds_read_b64_tr_b16 v[62:63], v64 offset:13312
  s_add_u32 s56, s40, 768
  s_add_u32 s57, s41, 1474560
  s_add_u32 m0, s43, 65536
  s_nop 0
  buffer_load_dwordx4 v10, s[4:7], s56 offen lds
  s_add_u32 m0, s43, 66560
  s_nop 0
  buffer_load_dwordx4 v11, s[4:7], s56 offen lds
  s_waitcnt lgkmcnt(6)
  v_mfma_f32_16x16x32_bf16 v[66:69], v[36:39], v[48:51], v[66:69]
  s_waitcnt lgkmcnt(4)
  v_mfma_f32_16x16x32_bf16 v[66:69], v[36:39], v[52:55], v[66:69]
  s_waitcnt lgkmcnt(2)
  v_mfma_f32_16x16x32_bf16 v[66:69], v[36:39], v[56:59], v[66:69]
  s_waitcnt lgkmcnt(0)
  v_mfma_f32_16x16x32_bf16 v[66:69], v[36:39], v[60:63], v[66:69]
  s_add_u32 m0, s43, 67584
  s_nop 0
  buffer_load_dwordx4 v12, s[4:7], s56 offen lds
  s_add_u32 m0, s43, 68608
  s_nop 0
  buffer_load_dwordx4 v13, s[4:7], s56 offen lds
  s_add_u32 m0, s43, 81920
  s_nop 0
  buffer_load_dwordx4 v14, s[8:11], s57 offen lds
  s_add_u32 m0, s43, 82944
  s_nop 0
  buffer_load_dwordx4 v15, s[8:11], s57 offen lds
  s_add_u32 m0, s43, 83968
  s_nop 0
  buffer_load_dwordx4 v16, s[8:11], s57 offen lds
  s_add_u32 m0, s43, 84992
  s_nop 0
  buffer_load_dwordx4 v17, s[8:11], s57 offen lds
  s_waitcnt vmcnt(8)
  s_waitcnt lgkmcnt(0)
  s_barrier
  ds_read_b128 v[176:179], v18 offset:32768
  ds_read_b128 v[180:183], v19 offset:32768
  ds_read_b128 v[184:187], v20 offset:32768
  ds_read_b128 v[188:191], v21 offset:32768
  ds_read_b64_tr_b16 v[48:49], v64 offset:32768
  ds_read_b64_tr_b16 v[50:51], v64 offset:33792
  ds_read_b64_tr_b16 v[52:53], v64 offset:36864
  ds_read_b64_tr_b16 v[54:55], v64 offset:37888
  ds_read_b64_tr_b16 v[56:57], v64 offset:40960
  ds_read_b64_tr_b16 v[58:59], v64 offset:41984
  ds_read_b64_tr_b16 v[60:61], v64 offset:45056
  ds_read_b64_tr_b16 v[62:63], v64 offset:46080
  s_add_u32 s56, s40, 896
  s_add_u32 s57, s41, 1720320
  s_add_u32 m0, s43, 98304
  s_nop 0
  buffer_load_dwordx4 v10, s[4:7], s56 offen lds
  s_add_u32 m0, s43, 99328
  s_nop 0
  buffer_load_dwordx4 v11, s[4:7], s56 offen lds
  s_waitcnt lgkmcnt(6)
  v_mfma_f32_16x16x32_bf16 v[66:69], v[36:39], v[48:51], v[66:69]
  s_waitcnt lgkmcnt(4)
  v_mfma_f32_16x16x32_bf16 v[66:69], v[36:39], v[52:55], v[66:69]
  s_waitcnt lgkmcnt(2)
  v_mfma_f32_16x16x32_bf16 v[66:69], v[36:39], v[56:59], v[66:69]
  s_waitcnt lgkmcnt(0)
  v_mfma_f32_16x16x32_bf16 v[66:69], v[36:39], v[60:63], v[66:69]
  s_add_u32 m0, s43, 100352
  s_nop 0
  buffer_load_dwordx4 v12, s[4:7], s56 offen lds
  s_add_u32 m0, s43, 101376
  s_nop 0
  buffer_load_dwordx4 v13, s[4:7], s56 offen lds
  s_add_u32 m0, s43, 114688
  s_nop 0
  buffer_load_dwordx4 v14, s[8:11], s57 offen lds
  s_add_u32 m0, s43, 115712
  s_nop 0
  buffer_load_dwordx4 v15, s[8:11], s57 offen lds
  s_add_u32 m0, s43, 116736
  s_nop 0
  buffer_load_dwordx4 v16, s[8:11], s57 offen lds
  s_add_u32 m0, s43, 117760
  s_nop 0
  buffer_load_dwordx4 v17, s[8:11], s57 offen lds
  s_waitcnt vmcnt(8)
  s_waitcnt lgkmcnt(0)
  s_barrier
  ds_read_b128 v[192:195], v22 offset:0
  ds_read_b128 v[196:199], v23 offset:0
  ds_read_b128 v[200:203], v24 offset:0
  ds_read_b128 v[204:207], v25 offset:0
  ds_read_b64_tr_b16 v[48:49], v65 offset:0
  ds_read_b64_tr_b16 v[50:51], v65 offset:1024
  ds_read_b64_tr_b16 v[52:53], v65 offset:4096
  ds_read_b64_tr_b16 v[54:55], v65 offset:5120
  ds_read_b64_tr_b16 v[56:57], v65 offset:8192
  ds_read_b64_tr_b16 v[58:59], v65 offset:9216
  ds_read_b64_tr_b16 v[60:61], v65 offset:12288
  ds_read_b64_tr_b16 v[62:63], v65 offset:13312
  s_add_u32 s56, s40, 1024
  s_add_u32 s57, s41, 1966080
  s_add_u32 m0, s43, 0
  s_nop 0
  buffer_load_dwordx4 v10, s[4:7], s56 offen lds
  s_add_u32 m0, s43, 1024
  s_nop 0
  buffer_load_dwordx4 v11, s[4:7], s56 offen lds
  s_waitcnt lgkmcnt(6)
  v_mfma_f32_16x16x32_bf16 v[66:69], v[36:39], v[48:51], v[66:69]
  s_waitcnt lgkmcnt(4)
  v_mfma_f32_16x16x32_bf16 v[66:69], v[36:39], v[52:55], v[66:69]
  s_waitcnt lgkmcnt(2)
  v_mfma_f32_16x16x32_bf16 v[66:69], v[36:39], v[56:59], v[66:69]
  s_waitcnt lgkmcnt(0)
  v_mfma_f32_16x16x32_bf16 v[66:69], v[36:39], v[60:63], v[66:69]
  s_add_u32 m0, s43, 2048
  s_nop 0
  buffer_load_dwordx4 v12, s[4:7], s56 offen lds
  s_add_u32 m0, s43, 3072
  s_nop 0
  buffer_load_dwordx4 v13, s[4:7], s56 offen lds
  s_add_u32 m0, s43, 16384
  s_nop 0
  buffer_load_dwordx4 v14, s[8:11], s57 offen lds
  s_add_u32 m0, s43, 17408
  s_nop 0
  buffer_load_dwordx4 v15, s[8:11], s57 offen lds
  s_add_u32 m0, s43, 18432
  s_nop 0
  buffer_load_dwordx4 v16, s[8:11], s57 offen lds
  s_add_u32 m0, s43, 19456
  s_nop 0
  buffer_load_dwordx4 v17, s[8:11], s57 offen lds
  s_add_u32 s58, s42, 0
  s_add_u32 m0, s44, 131072
  s_nop 0
  buffer_load_dwordx4 v34, s[12:15], s58 offen lds
  s_add_u32 m0, s44, 132096
  s_nop 0
  buffer_load_dwordx4 v35, s[12:15], s58 offen lds
  s_add_u32 m0, s44, 133120
  s_nop 0
  buffer_load_dwordx4 v40, s[12:15], s58 offen lds
  s_waitcnt vmcnt(11)
  s_waitcnt lgkmcnt(0)
  s_barrier
  ds_read_b128 v[208:211], v22 offset:32768
  ds_read_b128 v[212:215], v23 offset:32768
  ds_read_b128 v[216:219], v24 offset:32768
  ds_read_b128 v[220:223], v25 offset:32768
  ds_read_b64_tr_b16 v[48:49], v65 offset:32768
  ds_read_b64_tr_b16 v[50:51], v65 offset:33792
  ds_read_b64_tr_b16 v[52:53], v65 offset:36864
  ds_read_b64_tr_b16 v[54:55], v65 offset:37888
  ds_read_b64_tr_b16 v[56:57], v65 offset:40960
  ds_read_b64_tr_b16 v[58:59], v65 offset:41984
  ds_read_b64_tr_b16 v[60:61], v65 offset:45056
  ds_read_b64_tr_b16 v[62:63], v65 offset:46080
  s_add_u32 s56, s40, 1152
  s_add_u32 s57, s41, 2211840
  s_add_u32 m0, s43, 32768
  s_nop 0
  buffer_load_dwordx4 v10, s[4:7], s56 offen lds
  s_add_u32 m0, s43, 33792
  s_nop 0
  buffer_load_dwordx4 v11, s[4:7], s56 offen lds
  s_waitcnt lgkmcnt(6)
  v_mfma_f32_16x16x32_bf16 v[66:69], v[36:39], v[48:51], v[66:69]
  s_waitcnt lgkmcnt(4)
  v_mfma_f32_16x16x32_bf16 v[66:69], v[36:39], v[52:55], v[66:69]
  s_waitcnt lgkmcnt(2)
  v_mfma_f32_16x16x32_bf16 v[66:69], v[36:39], v[56:59], v[66:69]
  s_waitcnt lgkmcnt(0)
  v_mfma_f32_16x16x32_bf16 v[66:69], v[36:39], v[60:63], v[66:69]
  s_add_u32 m0, s43, 34816
  s_nop 0
  buffer_load_dwordx4 v12, s[4:7], s56 offen lds
  s_add_u32 m0, s43, 35840
  s_nop 0
  buffer_load_dwordx4 v13, s[4:7], s56 offen lds
  s_add_u32 m0, s43, 49152
  s_nop 0
  buffer_load_dwordx4 v14, s[8:11], s57 offen lds
  s_add_u32 m0, s43, 50176
  s_nop 0
  buffer_load_dwordx4 v15, s[8:11], s57 offen lds
  s_add_u32 m0, s43, 51200
  s_nop 0
  buffer_load_dwordx4 v16, s[8:11], s57 offen lds
  s_add_u32 m0, s43, 52224
  s_nop 0
  buffer_load_dwordx4 v17, s[8:11], s57 offen lds
  s_add_u32 s58, s42, 196608
  s_add_u32 m0, s44, 143360
  s_nop 0
  buffer_load_dwordx4 v34, s[12:15], s58 offen lds
  s_add_u32 m0, s44, 144384
  s_nop 0
  buffer_load_dwordx4 v35, s[12:15], s58 offen lds
  s_add_u32 m0, s44, 145408
  s_nop 0
  buffer_load_dwordx4 v40, s[12:15], s58 offen lds
  s_waitcnt vmcnt(14)
  s_waitcnt lgkmcnt(0)
  s_barrier
  ds_read_b128 v[224:227], v18 offset:0
  ds_read_b128 v[228:231], v19 offset:0
  ds_read_b128 v[232:235], v20 offset:0
  ds_read_b128 v[236:239], v21 offset:0
  ds_read_b64_tr_b16 v[48:49], v64 offset:0
  ds_read_b64_tr_b16 v[50:51], v64 offset:1024
  ds_read_b64_tr_b16 v[52:53], v64 offset:4096
  ds_read_b64_tr_b16 v[54:55], v64 offset:5120
  ds_read_b64_tr_b16 v[56:57], v64 offset:8192
  ds_read_b64_tr_b16 v[58:59], v64 offset:9216
  ds_read_b64_tr_b16 v[60:61], v64 offset:12288
  ds_read_b64_tr_b16 v[62:63], v64 offset:13312
  s_waitcnt lgkmcnt(6)
  v_mfma_f32_16x16x32_bf16 v[66:69], v[36:39], v[48:51], v[66:69]
  s_waitcnt lgkmcnt(4)
  v_mfma_f32_16x16x32_bf16 v[66:69], v[36:39], v[52:55], v[66:69]
  s_waitcnt lgkmcnt(2)
  v_mfma_f32_16x16x32_bf16 v[66:69], v[36:39], v[56:59], v[66:69]
  s_waitcnt lgkmcnt(0)
  v_mfma_f32_16x16x32_bf16 v[66:69], v[36:39], v[60:63], v[66:69]
  s_add_u32 s58, s42, 393216
  s_add_u32 m0, s44, 69632
  s_nop 0
  buffer_load_dwordx4 v34, s[12:15], s58 offen lds
  s_add_u32 m0, s44, 70656
  s_nop 0
  buffer_load_dwordx4 v35, s[12:15], s58 offen lds
  s_add_u32 m0, s44, 71680
  s_nop 0
  buffer_load_dwordx4 v40, s[12:15], s58 offen lds
  s_add_u32 s58, s42, 589824
  s_add_u32 m0, s44, 81920
  s_nop 0
  buffer_load_dwordx4 v34, s[12:15], s58 offen lds
  s_add_u32 m0, s44, 82944
  s_nop 0
  buffer_load_dwordx4 v35, s[12:15], s58 offen lds
  s_add_u32 m0, s44, 83968
  s_nop 0
  buffer_load_dwordx4 v40, s[12:15], s58 offen lds
  s_waitcnt vmcnt(9)
  s_waitcnt vmcnt(6)
  s_waitcnt lgkmcnt(0)
  s_barrier
  ds_read_b128 v[240:243], v18 offset:32768
  ds_read_b128 v[244:247], v19 offset:32768
  ds_read_b128 v[248:251], v20 offset:32768
  ds_read_b128 v[252:255], v21 offset:32768
  ds_read_b64_tr_b16 v[48:49], v64 offset:32768
  ds_read_b64_tr_b16 v[50:51], v64 offset:33792
  ds_read_b64_tr_b16 v[52:53], v64 offset:36864
  ds_read_b64_tr_b16 v[54:55], v64 offset:37888
  ds_read_b64_tr_b16 v[56:57], v64 offset:40960
  ds_read_b64_tr_b16 v[58:59], v64 offset:41984
  ds_read_b64_tr_b16 v[60:61], v64 offset:45056
  ds_read_b64_tr_b16 v[62:63], v64 offset:46080
  s_waitcnt lgkmcnt(6)
  v_mfma_f32_16x16x32_bf16 v[66:69], v[36:39], v[48:51], v[66:69]
  s_waitcnt lgkmcnt(4)
  v_mfma_f32_16x16x32_bf16 v[66:69], v[36:39], v[52:55], v[66:69]
  s_waitcnt lgkmcnt(2)
  v_mfma_f32_16x16x32_bf16 v[66:69], v[36:39], v[56:59], v[66:69]
  s_waitcnt lgkmcnt(0)
  v_mfma_f32_16x16x32_bf16 v[66:69], v[36:39], v[60:63], v[66:69]
  s_add_u32 s58, s42, 786432
  s_add_u32 m0, s44, 94208
  s_nop 0
  buffer_load_dwordx4 v34, s[12:15], s58 offen lds
  s_add_u32 m0, s44, 95232
  s_nop 0
  buffer_load_dwordx4 v35, s[12:15], s58 offen lds
  s_add_u32 m0, s44, 96256
  s_nop 0
  buffer_load_dwordx4 v40, s[12:15], s58 offen lds
  s_add_u32 s58, s42, 983040
  s_add_u32 m0, s44, 106496
  s_nop 0
  buffer_load_dwordx4 v34, s[12:15], s58 offen lds
  s_add_u32 m0, s44, 107520
  s_nop 0
  buffer_load_dwordx4 v35, s[12:15], s58 offen lds
  s_add_u32 m0, s44, 108544
  s_nop 0
  buffer_load_dwordx4 v40, s[12:15], s58 offen lds
  s_add_u32 s58, s42, 1179648
  s_add_u32 m0, s44, 118784
  s_nop 0
  buffer_load_dwordx4 v34, s[12:15], s58 offen lds
  s_add_u32 m0, s44, 119808
  s_nop 0
  buffer_load_dwordx4 v35, s[12:15], s58 offen lds
  s_add_u32 m0, s44, 120832
  s_nop 0
  buffer_load_dwordx4 v40, s[12:15], s58 offen lds
  v_and_b32 v3, 15, v2
  v_lshlrev_b32 v3, 2, v3
  s_lshl_b32 s37, s35, 7
  s_add_u32 s37, s37, 155648
  v_add_u32 v3, s37, v3
  s_nop 4
  s_mov_b64 exec, 0xffff
  ds_write_b32 v3, v66
  ds_write_b32 v3, v67 offset:64
  s_mov_b64 exec, -1
  s_waitcnt lgkmcnt(0)
  v_mov_b32 v3, 156736
  v_mov_b32 v8, 1
  s_mov_b64 exec, 1
  ds_add_u32 v3, v8
  s_mov_b64 exec, -1
  s_setprio 0
  s_add_u32 s24, s80, 11534336
  s_addc_u32 s25, s81, 0
  s_mov_b32 s26, 8912896
  s_mov_b32 s27, 0x20000
  s_mov_b32 s51, 0xbdd2d3e8
  s_lshl_b32 s47, s33, 1
  s_lshr_b32 s59, s35, 1
  s_add_u32 s47, s47, s59
  s_mul_i32 s47, s47, 68
  s_mul_i32 s59, s34, 3
  s_add_u32 s47, s47, s59
  s_lshl_b32 s47, s47, 12
  s_and_b32 s59, s35, 1
  s_lshl_b32 s59, s59, 11
  s_add_u32 s47, s47, s59
  v_mov_b32 v84, 0
  v_mov_b32 v85, 0
  v_mov_b32 v86, 0
  v_mov_b32 v87, 0
  v_mov_b32 v4, 0
  v_mov_b32 v5, 0
  v_mov_b32 v6, 0
  v_mov_b32 v7, 0
  v_mov_b32 v42, 0
  v_mov_b32 v43, 0
  v_mov_b32 v44, 0
  v_mov_b32 v45, 0
  s_mul_i32 s37, s35, 3072
  v_add_u32 v88, s37, v47
  v_add_u32 v89, s37, v46
  v_add_u32 v90, s37, v41
  s_waitcnt lgkmcnt(10)
  ds_read_b64_tr_b16 v[10:11], v47 offset:0
  ds_read_b64_tr_b16 v[12:13], v47 offset:768
  ds_read_b64_tr_b16 v[14:15], v47 offset:64
  ds_read_b64_tr_b16 v[16:17], v47 offset:832
  ds_read_b64_tr_b16 v[18:19], v47 offset:3072
  ds_read_b64_tr_b16 v[20:21], v47 offset:3840
  ds_read_b64_tr_b16 v[22:23], v47 offset:3136
  ds_read_b64_tr_b16 v[24:25], v47 offset:3904
  s_waitcnt lgkmcnt(4)
  v_mfma_f32_32x32x16_bf16 v[48:63], v[10:13], v[96:99], 0
  ds_read_b64_tr_b16 v[26:27], v47 offset:6144
  ds_read_b64_tr_b16 v[28:29], v47 offset:6912
  v_mfma_f32_32x32x16_bf16 v[64:79], v[14:17], v[96:99], 0
  ds_read_b64_tr_b16 v[30:31], v47 offset:6208
  ds_read_b64_tr_b16 v[32:33], v47 offset:6976
  ds_read_b64_tr_b16 v[80:81], v88 offset:128
  ds_read_b64_tr_b16 v[82:83], v88 offset:896
  s_waitcnt lgkmcnt(6)
  v_mfma_f32_32x32x16_bf16 v[48:63], v[18:21], v[100:103], v[48:63]
  ds_read_b64_tr_b16 v[10:11], v47 offset:9216
  ds_read_b64_tr_b16 v[12:13], v47 offset:9984
  v_mfma_f32_32x32x16_bf16 v[64:79], v[22:25], v[100:103], v[64:79]
  ds_read_b64_tr_b16 v[14:15], v47 offset:9280
  ds_read_b64_tr_b16 v[16:17], v47 offset:10048
  s_waitcnt lgkmcnt(4)
  v_mfma_f32_16x16x32_bf16 v[84:87], v[36:39], v[80:83], v[84:87]
  ds_read_b64_tr_b16 v[80:81], v88 offset:0
  ds_read_b64_tr_b16 v[82:83], v88 offset:768
  s_waitcnt lgkmcnt(8)
  v_mfma_f32_32x32x16_bf16 v[48:63], v[26:29], v[104:107], v[48:63]
  ds_read_b64_tr_b16 v[18:19], v47 offset:12288
  ds_read_b64_tr_b16 v[20:21], v47 offset:13056
  v_mfma_f32_32x32x16_bf16 v[64:79], v[30:33], v[104:107], v[64:79]
  ds_read_b64_tr_b16 v[22:23], v47 offset:12352
  ds_read_b64_tr_b16 v[24:25], v47 offset:13120
  s_waitcnt lgkmcnt(4)
  v_mfma_f32_16x16x32_bf16 v[4:7], v[36:39], v[80:83], v[4:7]
  ds_read_b64_tr_b16 v[80:81], v88 offset:64
  ds_read_b64_tr_b16 v[82:83], v88 offset:832
  s_waitcnt lgkmcnt(8)
  v_mfma_f32_32x32x16_bf16 v[48:63], v[10:13], v[108:111], v[48:63]
  ds_read_b64_tr_b16 v[26:27], v47 offset:15360
  ds_read_b64_tr_b16 v[28:29], v47 offset:16128
  v_mfma_f32_32x32x16_bf16 v[64:79], v[14:17], v[108:111], v[64:79]
  ds_read_b64_tr_b16 v[30:31], v47 offset:15424
  ds_read_b64_tr_b16 v[32:33], v47 offset:16192
  s_waitcnt lgkmcnt(4)
  v_mfma_f32_16x16x32_bf16 v[42:45], v[36:39], v[80:83], v[42:45]
  s_waitcnt vmcnt(9)
  v_mov_b32 v3, 156728
  v_mov_b32 v8, 1
  s_mov_b64 exec, 1
  ds_add_u32 v3, v8
  s_mov_b64 exec, -1
  s_waitcnt lgkmcnt(6)
  v_mfma_f32_32x32x16_bf16 v[48:63], v[18:21], v[112:115], v[48:63]
  ds_read_b64_tr_b16 v[10:11], v47 offset:18432
  ds_read_b64_tr_b16 v[12:13], v47 offset:19200
  v_mfma_f32_32x32x16_bf16 v[64:79], v[22:25], v[112:115], v[64:79]
  ds_read_b64_tr_b16 v[14:15], v47 offset:18496
  ds_read_b64_tr_b16 v[16:17], v47 offset:19264
  ds_read_b64_tr_b16 v[80:81], v88 offset:12416
  ds_read_b64_tr_b16 v[82:83], v88 offset:13184
  s_waitcnt lgkmcnt(6)
  v_mfma_f32_32x32x16_bf16 v[48:63], v[26:29], v[116:119], v[48:63]
  ds_read_b64_tr_b16 v[18:19], v47 offset:21504
  ds_read_b64_tr_b16 v[20:21], v47 offset:22272
  v_mfma_f32_32x32x16_bf16 v[64:79], v[30:33], v[116:119], v[64:79]
  ds_read_b64_tr_b16 v[22:23], v47 offset:21568
  ds_read_b64_tr_b16 v[24:25], v47 offset:22336
  s_waitcnt lgkmcnt(4)
  v_mfma_f32_16x16x32_bf16 v[84:87], v[36:39], v[80:83], v[84:87]
  ds_read_b64_tr_b16 v[80:81], v88 offset:12288
  ds_read_b64_tr_b16 v[82:83], v88 offset:13056
  v_mov_b32 v3, 156728
  s_mov_b32 s37, 0
lw_57:
  ds_read_b32 v8, v3
  s_waitcnt lgkmcnt(0)
  v_cmp_gt_u32 vcc, 4, v8
  s_cbranch_vccz lwd_58
  s_add_u32 s37, s37, 1
  s_cmp_lt_u32 s37, 640000
  s_cbranch_scc0 lwd_58
  s_sleep 1
  s_branch lw_57
lwd_58:
  s_waitcnt lgkmcnt(8)
  v_mfma_f32_32x32x16_bf16 v[48:63], v[10:13], v[120:123], v[48:63]
  ds_read_b64_tr_b16 v[26:27], v46 offset:0
  ds_read_b64_tr_b16 v[28:29], v46 offset:768
  v_mfma_f32_32x32x16_bf16 v[64:79], v[14:17], v[120:123], v[64:79]
  ds_read_b64_tr_b16 v[30:31], v46 offset:64
  ds_read_b64_tr_b16 v[32:33], v46 offset:832
  s_waitcnt lgkmcnt(4)
  v_mfma_f32_16x16x32_bf16 v[4:7], v[36:39], v[80:83], v[4:7]
  ds_read_b64_tr_b16 v[80:81], v88 offset:12352
  ds_read_b64_tr_b16 v[82:83], v88 offset:13120
  s_waitcnt lgkmcnt(8)
  v_mfma_f32_32x32x16_bf16 v[48:63], v[18:21], v[124:127], v[48:63]
  ds_read_b64_tr_b16 v[10:11], v46 offset:3072
  ds_read_b64_tr_b16 v[12:13], v46 offset:3840
  v_mfma_f32_32x32x16_bf16 v[64:79], v[22:25], v[124:127], v[64:79]
  ds_read_b64_tr_b16 v[14:15], v46 offset:3136
  ds_read_b64_tr_b16 v[16:17], v46 offset:3904
  s_waitcnt lgkmcnt(4)
  v_mfma_f32_16x16x32_bf16 v[42:45], v[36:39], v[80:83], v[42:45]
  v_mov_b32 v3, 156736
  s_mov_b32 s37, 0
lw_59:
  ds_read_b32 v8, v3
  s_waitcnt lgkmcnt(0)
  v_cmp_gt_u32 vcc, 4, v8
  s_cbranch_vccz lwd_60
  s_add_u32 s37, s37, 1
  s_cmp_lt_u32 s37, 640000
  s_cbranch_scc0 lwd_60
  s_sleep 1
  s_branch lw_59
lwd_60:
  v_mov_b32 v3, 156724
  s_mov_b32 s37, 0
lw_61:
  ds_read_b32 v8, v3
  s_waitcnt lgkmcnt(0)
  v_cmp_gt_u32 vcc, 4, v8
  s_cbranch_vccz lwd_62
  s_add_u32 s37, s37, 1
  s_cmp_lt_u32 s37, 640000
  s_cbranch_scc0 lwd_62
  s_sleep 1
  s_branch lw_61
lwd_62:
  s_setprio 2
  s_waitcnt lgkmcnt(6)
  v_mfma_f32_32x32x16_bf16 v[48:63], v[26:29], v[128:131], v[48:63]
  ds_read_b64_tr_b16 v[18:19], v46 offset:6144
  ds_read_b64_tr_b16 v[20:21], v46 offset:6912
  s_add_u32 s58, s42, 1376256
  s_add_u32 m0, s44, 20480
  s_nop 0
  buffer_load_dwordx4 v34, s[12:15], s58 offen lds
  v_mfma_f32_32x32x16_bf16 v[64:79], v[30:33], v[128:131], v[64:79]
  ds_read_b64_tr_b16 v[22:23], v46 offset:6208
  ds_read_b64_tr_b16 v[24:25], v46 offset:6976
  s_add_u32 m0, s44, 21504
  s_nop 0
  buffer_load_dwordx4 v35, s[12:15], s58 offen lds
  ds_read_b64_tr_b16 v[80:81], v89 offset:128
  ds_read_b64_tr_b16 v[82:83], v89 offset:896
  s_waitcnt lgkmcnt(6)
  v_mfma_f32_32x32x16_bf16 v[48:63], v[10:13], v[132:135], v[48:63]
  ds_read_b64_tr_b16 v[26:27], v46 offset:9216
  ds_read_b64_tr_b16 v[28:29], v46 offset:9984
  s_add_u32 m0, s44, 22528
  s_nop 0
  buffer_load_dwordx4 v40, s[12:15], s58 offen lds
  v_mfma_f32_32x32x16_bf16 v[64:79], v[14:17], v[132:135], v[64:79]
  ds_read_b64_tr_b16 v[30:31], v46 offset:9280
  ds_read_b64_tr_b16 v[32:33], v46 offset:10048
  s_add_u32 s58, s42, 1572864
  s_add_u32 m0, s44, 32768
  s_nop 0
  buffer_load_dwordx4 v34, s[12:15], s58 offen lds
  s_waitcnt lgkmcnt(4)
  v_mfma_f32_16x16x32_bf16 v[84:87], v[36:39], v[80:83], v[84:87]
  ds_read_b64_tr_b16 v[80:81], v89 offset:0
  ds_read_b64_tr_b16 v[82:83], v89 offset:768
  s_waitcnt lgkmcnt(8)
  v_mfma_f32_32x32x16_bf16 v[48:63], v[18:21], v[136:139], v[48:63]
  ds_read_b64_tr_b16 v[10:11], v46 offset:12288
  ds_read_b64_tr_b16 v[12:13], v46 offset:13056
  s_add_u32 m0, s44, 33792
  s_nop 0
  buffer_load_dwordx4 v35, s[12:15], s58 offen lds
  v_mfma_f32_32x32x16_bf16 v[64:79], v[22:25], v[136:139], v[64:79]
  ds_read_b64_tr_b16 v[14:15], v46 offset:12352
  ds_read_b64_tr_b16 v[16:17], v46 offset:13120
  s_add_u32 m0, s44, 34816
  s_nop 0
  buffer_load_dwordx4 v40, s[12:15], s58 offen lds
  s_waitcnt lgkmcnt(4)
  v_mfma_f32_16x16x32_bf16 v[4:7], v[36:39], v[80:83], v[4:7]
  ds_read_b64_tr_b16 v[80:81], v89 offset:64
  ds_read_b64_tr_b16 v[82:83], v89 offset:832
  s_waitcnt lgkmcnt(8)
  v_mfma_f32_32x32x16_bf16 v[48:63], v[26:29], v[140:143], v[48:63]
  ds_read_b64_tr_b16 v[18:19], v46 offset:15360
  ds_read_b64_tr_b16 v[20:21], v46 offset:16128
  s_add_u32 s58, s42, 1769472
  s_add_u32 m0, s44, 45056
  s_nop 0
  buffer_load_dwordx4 v34, s[12:15], s58 offen lds
  v_mfma_f32_32x32x16_bf16 v[64:79], v[30:33], v[140:143], v[64:79]
  ds_read_b64_tr_b16 v[22:23], v46 offset:15424
  ds_read_b64_tr_b16 v[24:25], v46 offset:16192
  s_add_u32 m0, s44, 46080
  s_nop 0
  buffer_load_dwordx4 v35, s[12:15], s58 offen lds
  s_waitcnt lgkmcnt(4)
  v_mfma_f32_16x16x32_bf16 v[42:45], v[36:39], v[80:83], v[42:45]
  s_waitcnt vmcnt(8)
  v_mov_b32 v3, 156728
  v_mov_b32 v8, 1
  s_mov_b64 exec, 1
  ds_add_u32 v3, v8
  s_mov_b64 exec, -1
  s_waitcnt lgkmcnt(6)
  v_mfma_f32_32x32x16_bf16 v[48:63], v[10:13], v[144:147], v[48:63]
  ds_read_b64_tr_b16 v[26:27], v46 offset:18432
  ds_read_b64_tr_b16 v[28:29], v46 offset:19200
  s_add_u32 m0, s44, 47104
  s_nop 0
  buffer_load_dwordx4 v40, s[12:15], s58 offen lds
  v_mfma_f32_32x32x16_bf16 v[64:79], v[14:17], v[144:147], v[64:79]
  ds_read_b64_tr_b16 v[30:31], v46 offset:18496
  ds_read_b64_tr_b16 v[32:33], v46 offset:19264
  ds_read_b64_tr_b16 v[80:81], v89 offset:12416
  ds_read_b64_tr_b16 v[82:83], v89 offset:13184
  s_waitcnt lgkmcnt(6)
  v_mfma_f32_32x32x16_bf16 v[48:63], v[18:21], v[148:151], v[48:63]
  ds_read_b64_tr_b16 v[10:11], v46 offset:21504
  ds_read_b64_tr_b16 v[12:13], v46 offset:22272
  v_mfma_f32_32x32x16_bf16 v[64:79], v[22:25], v[148:151], v[64:79]
  ds_read_b64_tr_b16 v[14:15], v46 offset:21568
  ds_read_b64_tr_b16 v[16:17], v46 offset:22336
  s_waitcnt lgkmcnt(4)
  v_mfma_f32_16x16x32_bf16 v[84:87], v[36:39], v[80:83], v[84:87]
  ds_read_b64_tr_b16 v[80:81], v89 offset:12288
  ds_read_b64_tr_b16 v[82:83], v89 offset:13056
  v_mov_b32 v3, 156728
  s_mov_b32 s37, 0
lw_63:
  ds_read_b32 v8, v3
  s_waitcnt lgkmcnt(0)
  v_cmp_gt_u32 vcc, 8, v8
  s_cbranch_vccz lwd_64
  s_add_u32 s37, s37, 1
  s_cmp_lt_u32 s37, 640000
  s_cbranch_scc0 lwd_64
  s_sleep 1
  s_branch lw_63
lwd_64:
  s_waitcnt lgkmcnt(8)
  v_mfma_f32_32x32x16_bf16 v[48:63], v[26:29], v[152:155], v[48:63]
  ds_read_b64_tr_b16 v[18:19], v46 offset:24576
  ds_read_b64_tr_b16 v[20:21], v46 offset:25344
  v_mfma_f32_32x32x16_bf16 v[64:79], v[30:33], v[152:155], v[64:79]
  ds_read_b64_tr_b16 v[22:23], v46 offset:24640
  ds_read_b64_tr_b16 v[24:25], v46 offset:25408
  s_waitcnt lgkmcnt(4)
  v_mfma_f32_16x16x32_bf16 v[4:7], v[36:39], v[80:83], v[4:7]
  ds_read_b64_tr_b16 v[80:81], v89 offset:12352
  ds_read_b64_tr_b16 v[82:83], v89 offset:13120
  s_waitcnt lgkmcnt(8)
  v_mfma_f32_32x32x16_bf16 v[48:63], v[10:13], v[156:159], v[48:63]
  ds_read_b64_tr_b16 v[26:27], v46 offset:27648
  ds_read_b64_tr_b16 v[28:29], v46 offset:28416
  v_mfma_f32_32x32x16_bf16 v[64:79], v[14:17], v[156:159], v[64:79]
  ds_read_b64_tr_b16 v[30:31], v46 offset:27712
  ds_read_b64_tr_b16 v[32:33], v46 offset:28480
  s_waitcnt lgkmcnt(4)
  v_mfma_f32_16x16x32_bf16 v[42:45], v[36:39], v[80:83], v[42:45]
  s_waitcnt lgkmcnt(6)
  v_mfma_f32_32x32x16_bf16 v[48:63], v[18:21], v[160:163], v[48:63]
  ds_read_b64_tr_b16 v[10:11], v46 offset:30720
  ds_read_b64_tr_b16 v[12:13], v46 offset:31488
  v_mfma_f32_32x32x16_bf16 v[64:79], v[22:25], v[160:163], v[64:79]
  ds_read_b64_tr_b16 v[14:15], v46 offset:30784
  ds_read_b64_tr_b16 v[16:17], v46 offset:31552
  ds_read_b64_tr_b16 v[80:81], v89 offset:24704
  ds_read_b64_tr_b16 v[82:83], v89 offset:25472
  s_waitcnt lgkmcnt(6)
  v_mfma_f32_32x32x16_bf16 v[48:63], v[26:29], v[164:167], v[48:63]
  ds_read_b64_tr_b16 v[18:19], v46 offset:33792
  ds_read_b64_tr_b16 v[20:21], v46 offset:34560
  v_mfma_f32_32x32x16_bf16 v[64:79], v[30:33], v[164:167], v[64:79]
  ds_read_b64_tr_b16 v[22:23], v46 offset:33856
  ds_read_b64_tr_b16 v[24:25], v46 offset:34624
  s_waitcnt lgkmcnt(4)
  v_mfma_f32_16x16x32_bf16 v[84:87], v[36:39], v[80:83], v[84:87]
  ds_read_b64_tr_b16 v[80:81], v89 offset:24576
  ds_read_b64_tr_b16 v[82:83], v89 offset:25344
  s_waitcnt lgkmcnt(8)
  v_mfma_f32_32x32x16_bf16 v[48:63], v[10:13], v[168:171], v[48:63]
  ds_read_b64_tr_b16 v[26:27], v46 offset:36864
  ds_read_b64_tr_b16 v[28:29], v46 offset:37632
  v_mfma_f32_32x32x16_bf16 v[64:79], v[14:17], v[168:171], v[64:79]
  ds_read_b64_tr_b16 v[30:31], v46 offset:36928
  ds_read_b64_tr_b16 v[32:33], v46 offset:37696
  s_waitcnt lgkmcnt(4)
  v_mfma_f32_16x16x32_bf16 v[4:7], v[36:39], v[80:83], v[4:7]
  ds_read_b64_tr_b16 v[80:81], v89 offset:24640
  ds_read_b64_tr_b16 v[82:83], v89 offset:25408
  s_waitcnt lgkmcnt(8)
  v_mfma_f32_32x32x16_bf16 v[48:63], v[18:21], v[172:175], v[48:63]
  ds_read_b64_tr_b16 v[10:11], v46 offset:39936
  ds_read_b64_tr_b16 v[12:13], v46 offset:40704
  v_mfma_f32_32x32x16_bf16 v[64:79], v[22:25], v[172:175], v[64:79]
  ds_read_b64_tr_b16 v[14:15], v46 offset:40000
  ds_read_b64_tr_b16 v[16:17], v46 offset:40768
  s_waitcnt lgkmcnt(4)
  v_mfma_f32_16x16x32_bf16 v[42:45], v[36:39], v[80:83], v[42:45]
  s_waitcnt lgkmcnt(6)
  v_mfma_f32_32x32x16_bf16 v[48:63], v[26:29], v[176:179], v[48:63]
  ds_read_b64_tr_b16 v[18:19], v46 offset:43008
  ds_read_b64_tr_b16 v[20:21], v46 offset:43776
  v_mfma_f32_32x32x16_bf16 v[64:79], v[30:33], v[176:179], v[64:79]
  ds_read_b64_tr_b16 v[22:23], v46 offset:43072
  ds_read_b64_tr_b16 v[24:25], v46 offset:43840
  ds_read_b64_tr_b16 v[80:81], v89 offset:36992
  ds_read_b64_tr_b16 v[82:83], v89 offset:37760
  s_waitcnt lgkmcnt(6)
  v_mfma_f32_32x32x16_bf16 v[48:63], v[10:13], v[180:183], v[48:63]
  ds_read_b64_tr_b16 v[26:27], v46 offset:46080
  ds_read_b64_tr_b16 v[28:29], v46 offset:46848
  v_mfma_f32_32x32x16_bf16 v[64:79], v[14:17], v[180:183], v[64:79]
  ds_read_b64_tr_b16 v[30:31], v46 offset:46144
  ds_read_b64_tr_b16 v[32:33], v46 offset:46912
  s_waitcnt lgkmcnt(4)
  v_mfma_f32_16x16x32_bf16 v[84:87], v[36:39], v[80:83], v[84:87]
  ds_read_b64_tr_b16 v[80:81], v89 offset:36864
  ds_read_b64_tr_b16 v[82:83], v89 offset:37632
  s_waitcnt lgkmcnt(8)
  v_mfma_f32_32x32x16_bf16 v[48:63], v[18:21], v[184:187], v[48:63]
  ds_read_b64_tr_b16 v[10:11], v46 offset:49152
  ds_read_b64_tr_b16 v[12:13], v46 offset:49920
  v_mfma_f32_32x32x16_bf16 v[64:79], v[22:25], v[184:187], v[64:79]
  ds_read_b64_tr_b16 v[14:15], v46 offset:49216
  ds_read_b64_tr_b16 v[16:17], v46 offset:49984
  s_waitcnt lgkmcnt(4)
  v_mfma_f32_16x16x32_bf16 v[4:7], v[36:39], v[80:83], v[4:7]
  ds_read_b64_tr_b16 v[80:81], v89 offset:36928
  ds_read_b64_tr_b16 v[82:83], v89 offset:37696
  s_waitcnt lgkmcnt(8)
  v_mfma_f32_32x32x16_bf16 v[48:63], v[26:29], v[188:191], v[48:63]
  ds_read_b64_tr_b16 v[18:19], v46 offset:52224
  ds_read_b64_tr_b16 v[20:21], v46 offset:52992
  v_mfma_f32_32x32x16_bf16 v[64:79], v[30:33], v[188:191], v[64:79]
  ds_read_b64_tr_b16 v[22:23], v46 offset:52288
  ds_read_b64_tr_b16 v[24:25], v46 offset:53056
  s_waitcnt lgkmcnt(4)
  v_mfma_f32_16x16x32_bf16 v[42:45], v[36:39], v[80:83], v[42:45]
  s_waitcnt vmcnt(0)
  v_mov_b32 v3, 156728
  v_mov_b32 v8, 1
  s_mov_b64 exec, 1
  ds_add_u32 v3, v8
  s_mov_b64 exec, -1
  s_waitcnt lgkmcnt(6)
  v_mfma_f32_32x32x16_bf16 v[48:63], v[10:13], v[192:195], v[48:63]
  ds_read_b64_tr_b16 v[26:27], v46 offset:55296
  ds_read_b64_tr_b16 v[28:29], v46 offset:56064
  v_mfma_f32_32x32x16_bf16 v[64:79], v[14:17], v[192:195], v[64:79]
  ds_read_b64_tr_b16 v[30:31], v46 offset:55360
  ds_read_b64_tr_b16 v[32:33], v46 offset:56128
  ds_read_b64_tr_b16 v[80:81], v89 offset:49280
  ds_read_b64_tr_b16 v[82:83], v89 offset:50048
  s_waitcnt lgkmcnt(6)
  v_mfma_f32_32x32x16_bf16 v[48:63], v[18:21], v[196:199], v[48:63]
  ds_read_b64_tr_b16 v[10:11], v46 offset:58368
  ds_read_b64_tr_b16 v[12:13], v46 offset:59136
  v_mfma_f32_32x32x16_bf16 v[64:79], v[22:25], v[196:199], v[64:79]
  ds_read_b64_tr_b16 v[14:15], v46 offset:58432
  ds_read_b64_tr_b16 v[16:17], v46 offset:59200
  s_waitcnt lgkmcnt(4)
  v_mfma_f32_16x16x32_bf16 v[84:87], v[36:39], v[80:83], v[84:87]
  ds_read_b64_tr_b16 v[80:81], v89 offset:49152
  ds_read_b64_tr_b16 v[82:83], v89 offset:49920
  v_mov_b32 v3, 156728
  s_mov_b32 s37, 0
lw_65:
  ds_read_b32 v8, v3
  s_waitcnt lgkmcnt(0)
  v_cmp_gt_u32 vcc, 12, v8
  s_cbranch_vccz lwd_66
  s_add_u32 s37, s37, 1
  s_cmp_lt_u32 s37, 640000
  s_cbranch_scc0 lwd_66
  s_sleep 1
  s_branch lw_65
lwd_66:
  s_waitcnt lgkmcnt(8)
  v_mfma_f32_32x32x16_bf16 v[48:63], v[26:29], v[200:203], v[48:63]
  ds_read_b64_tr_b16 v[18:19], v41 offset:20480
  ds_read_b64_tr_b16 v[20:21], v41 offset:21248
  v_mfma_f32_32x32x16_bf16 v[64:79], v[30:33], v[200:203], v[64:79]
  ds_read_b64_tr_b16 v[22:23], v41 offset:20544
  ds_read_b64_tr_b16 v[24:25], v41 offset:21312
  s_waitcnt lgkmcnt(4)
  v_mfma_f32_16x16x32_bf16 v[4:7], v[36:39], v[80:83], v[4:7]
  ds_read_b64_tr_b16 v[80:81], v89 offset:49216
  ds_read_b64_tr_b16 v[82:83], v89 offset:49984
  s_waitcnt lgkmcnt(8)
  v_mfma_f32_32x32x16_bf16 v[48:63], v[10:13], v[204:207], v[48:63]
  ds_read_b64_tr_b16 v[26:27], v41 offset:23552
  ds_read_b64_tr_b16 v[28:29], v41 offset:24320
  v_mfma_f32_32x32x16_bf16 v[64:79], v[14:17], v[204:207], v[64:79]
  ds_read_b64_tr_b16 v[30:31], v41 offset:23616
  ds_read_b64_tr_b16 v[32:33], v41 offset:24384
  s_waitcnt lgkmcnt(4)
  v_mfma_f32_16x16x32_bf16 v[42:45], v[36:39], v[80:83], v[42:45]
  s_waitcnt lgkmcnt(6)
  v_mfma_f32_32x32x16_bf16 v[48:63], v[18:21], v[208:211], v[48:63]
  ds_read_b64_tr_b16 v[10:11], v41 offset:26624
  ds_read_b64_tr_b16 v[12:13], v41 offset:27392
  v_mfma_f32_32x32x16_bf16 v[64:79], v[22:25], v[208:211], v[64:79]
  ds_read_b64_tr_b16 v[14:15], v41 offset:26688
  ds_read_b64_tr_b16 v[16:17], v41 offset:27456
  ds_read_b64_tr_b16 v[80:81], v90 offset:20608
  ds_read_b64_tr_b16 v[82:83], v90 offset:21376
  s_waitcnt lgkmcnt(6)
  v_mfma_f32_32x32x16_bf16 v[48:63], v[26:29], v[212:215], v[48:63]
  ds_read_b64_tr_b16 v[18:19], v41 offset:29696
  ds_read_b64_tr_b16 v[20:21], v41 offset:30464
  v_mfma_f32_32x32x16_bf16 v[64:79], v[30:33], v[212:215], v[64:79]
  ds_read_b64_tr_b16 v[22:23], v41 offset:29760
  ds_read_b64_tr_b16 v[24:25], v41 offset:30528
  s_waitcnt lgkmcnt(4)
  v_mfma_f32_16x16x32_bf16 v[84:87], v[36:39], v[80:83], v[84:87]
  ds_read_b64_tr_b16 v[80:81], v90 offset:20480
  ds_read_b64_tr_b16 v[82:83], v90 offset:21248
  s_waitcnt lgkmcnt(8)
  v_mfma_f32_32x32x16_bf16 v[48:63], v[10:13], v[216:219], v[48:63]
  ds_read_b64_tr_b16 v[26:27], v41 offset:32768
  ds_read_b64_tr_b16 v[28:29], v41 offset:33536
  v_mfma_f32_32x32x16_bf16 v[64:79], v[14:17], v[216:219], v[64:79]
  ds_read_b64_tr_b16 v[30:31], v41 offset:32832
  ds_read_b64_tr_b16 v[32:33], v41 offset:33600
  v_lshrrev_b32 v3, 5, v2
  v_lshlrev_b32 v34, 4, v3
  v_add_u32 v35, 156928, v34
  s_mul_i32 s37, s35, 384
  s_add_u32 s37, s37, 159872
  v_add_u32 v34, s37, v34
  v_mov_b32 v40, 0xc0135761
  v_bfe_u32 v8, v2, 4, 1
  v_lshlrev_b32 v91, 10, v8
  v_lshrrev_b32 v3, 5, v2
  v_lshl_add_u32 v91, v3, 8, v91
  v_and_b32 v8, 15, v2
  v_lshl_add_u32 v91, v8, 4, v91
  v_and_b32 v8, 31, v2
  s_lshl_b32 s37, s35, 5
  v_add_u32 v8, s37, v8
  v_lshlrev_b32 v8, 3, v8
  v_add_u32 v92, 157312, v8
  v_and_b32 v3, 15, v2
  v_lshlrev_b32 v3, 2, v3
  s_mul_i32 s37, s35, 384
  s_add_u32 s37, s37, 158336
  v_add_u32 v9, s37, v3
  s_waitcnt lgkmcnt(4)
  v_mfma_f32_16x16x32_bf16 v[4:7], v[36:39], v[80:83], v[4:7]
  ds_read_b64_tr_b16 v[80:81], v90 offset:20544
  ds_read_b64_tr_b16 v[82:83], v90 offset:21312
  s_waitcnt lgkmcnt(8)
  v_mfma_f32_32x32x16_bf16 v[48:63], v[18:21], v[220:223], v[48:63]
  ds_read_b64_tr_b16 v[10:11], v41 offset:35840
  ds_read_b64_tr_b16 v[12:13], v41 offset:36608
  v_mfma_f32_32x32x16_bf16 v[64:79], v[22:25], v[220:223], v[64:79]
  ds_read_b64_tr_b16 v[14:15], v41 offset:35904
  ds_read_b64_tr_b16 v[16:17], v41 offset:36672
  s_waitcnt lgkmcnt(4)
  v_mfma_f32_16x16x32_bf16 v[42:45], v[36:39], v[80:83], v[42:45]
  s_waitcnt lgkmcnt(6)
  v_mfma_f32_32x32x16_bf16 v[48:63], v[26:29], v[224:227], v[48:63]
  ds_read_b64_tr_b16 v[18:19], v41 offset:38912
  ds_read_b64_tr_b16 v[20:21], v41 offset:39680
  v_mfma_f32_32x32x16_bf16 v[64:79], v[30:33], v[224:227], v[64:79]
  ds_read_b64_tr_b16 v[22:23], v41 offset:38976
  ds_read_b64_tr_b16 v[24:25], v41 offset:39744
  ds_read_b64_tr_b16 v[80:81], v90 offset:32896
  ds_read_b64_tr_b16 v[82:83], v90 offset:33664
  s_waitcnt lgkmcnt(6)
  v_mfma_f32_32x32x16_bf16 v[48:63], v[10:13], v[228:231], v[48:63]
  ds_read_b64_tr_b16 v[26:27], v41 offset:41984
  ds_read_b64_tr_b16 v[28:29], v41 offset:42752
  v_mfma_f32_32x32x16_bf16 v[64:79], v[14:17], v[228:231], v[64:79]
  ds_read_b64_tr_b16 v[30:31], v41 offset:42048
  ds_read_b64_tr_b16 v[32:33], v41 offset:42816
  s_waitcnt lgkmcnt(4)
  v_mfma_f32_16x16x32_bf16 v[84:87], v[36:39], v[80:83], v[84:87]
  ds_read_b64_tr_b16 v[80:81], v90 offset:32768
  ds_read_b64_tr_b16 v[82:83], v90 offset:33536
  s_waitcnt lgkmcnt(8)
  v_mfma_f32_32x32x16_bf16 v[48:63], v[18:21], v[232:235], v[48:63]
  ds_read_b64_tr_b16 v[10:11], v41 offset:45056
  ds_read_b64_tr_b16 v[12:13], v41 offset:45824
  v_mfma_f32_32x32x16_bf16 v[64:79], v[22:25], v[232:235], v[64:79]
  ds_read_b64_tr_b16 v[14:15], v41 offset:45120
  ds_read_b64_tr_b16 v[16:17], v41 offset:45888
  s_waitcnt lgkmcnt(4)
  v_mfma_f32_16x16x32_bf16 v[4:7], v[36:39], v[80:83], v[4:7]
  ds_read_b64_tr_b16 v[80:81], v90 offset:32832
  ds_read_b64_tr_b16 v[82:83], v90 offset:33600
  s_waitcnt lgkmcnt(8)
  v_mfma_f32_32x32x16_bf16 v[48:63], v[26:29], v[236:239], v[48:63]
  ds_read_b64_tr_b16 v[18:19], v41 offset:48128
  ds_read_b64_tr_b16 v[20:21], v41 offset:48896
  v_mfma_f32_32x32x16_bf16 v[64:79], v[30:33], v[236:239], v[64:79]
  ds_read_b64_tr_b16 v[22:23], v41 offset:48192
  ds_read_b64_tr_b16 v[24:25], v41 offset:48960
  s_waitcnt lgkmcnt(4)
  v_mfma_f32_16x16x32_bf16 v[42:45], v[36:39], v[80:83], v[42:45]
  s_waitcnt lgkmcnt(6)
  v_mfma_f32_32x32x16_bf16 v[48:63], v[10:13], v[240:243], v[48:63]
  ds_read_b64_tr_b16 v[26:27], v41 offset:51200
  ds_read_b64_tr_b16 v[28:29], v41 offset:51968
  v_mfma_f32_32x32x16_bf16 v[64:79], v[14:17], v[240:243], v[64:79]
  ds_read_b64_tr_b16 v[30:31], v41 offset:51264
  ds_read_b64_tr_b16 v[32:33], v41 offset:52032
  ds_read_b64_tr_b16 v[80:81], v90 offset:45184
  ds_read_b64_tr_b16 v[82:83], v90 offset:45952
  s_waitcnt lgkmcnt(6)
  v_mfma_f32_32x32x16_bf16 v[48:63], v[18:21], v[244:247], v[48:63]
  ds_read_b64_tr_b16 v[10:11], v41 offset:54272
  ds_read_b64_tr_b16 v[12:13], v41 offset:55040
  v_mfma_f32_32x32x16_bf16 v[64:79], v[22:25], v[244:247], v[64:79]
  ds_read_b64_tr_b16 v[14:15], v41 offset:54336
  ds_read_b64_tr_b16 v[16:17], v41 offset:55104
  s_waitcnt lgkmcnt(4)
  v_mfma_f32_16x16x32_bf16 v[84:87], v[36:39], v[80:83], v[84:87]
  ds_read_b64_tr_b16 v[80:81], v90 offset:45056
  ds_read_b64_tr_b16 v[82:83], v90 offset:45824
  s_waitcnt lgkmcnt(8)
  v_mfma_f32_32x32x16_bf16 v[48:63], v[26:29], v[248:251], v[48:63]
  v_mfma_f32_32x32x16_bf16 v[64:79], v[30:33], v[248:251], v[64:79]
  s_waitcnt lgkmcnt(0)
  v_mfma_f32_16x16x32_bf16 v[4:7], v[36:39], v[80:83], v[4:7]
  ds_read_b64_tr_b16 v[80:81], v90 offset:45120
  ds_read_b64_tr_b16 v[82:83], v90 offset:45888
  s_waitcnt lgkmcnt(4)
  v_mfma_f32_32x32x16_bf16 v[48:63], v[10:13], v[252:255], v[48:63]
  v_mfma_f32_32x32x16_bf16 v[64:79], v[14:17], v[252:255], v[64:79]
  s_waitcnt lgkmcnt(0)
  v_mfma_f32_16x16x32_bf16 v[42:45], v[36:39], v[80:83], v[42:45]
  s_nop 7
  s_mov_b64 exec, 0xffff
  ds_write_b32 v9, v4
  ds_write_b32 v9, v5 offset:64
  ds_write_b32 v9, v42 offset:128
  ds_write_b32 v9, v43 offset:192
  ds_write_b32 v9, v84 offset:256
  ds_write_b32 v9, v85 offset:320
  s_mov_b64 exec, -1
  v_mov_b32 v44, v91
  v_mov_b32 v45, v92
  ds_read_b64_tr_b16 v[10:11], v41 offset:20608
  ds_read_b64_tr_b16 v[12:13], v41 offset:21376
  ds_read_b64_tr_b16 v[14:15], v41 offset:23680
  ds_read_b64_tr_b16 v[16:17], v41 offset:24448
  ds_read_b64_tr_b16 v[18:19], v41 offset:26752
  ds_read_b64_tr_b16 v[20:21], v41 offset:27520
  ds_read_b64_tr_b16 v[22:23], v41 offset:29824
  ds_read_b64_tr_b16 v[24:25], v41 offset:30592
  s_waitcnt lgkmcnt(8)
  v_mov_b32 v3, 156728
  v_mov_b32 v8, 1
  s_mov_b64 exec, 1
  ds_add_u32 v3, v8
  s_mov_b64 exec, -1
  s_waitcnt lgkmcnt(6)
  v_mfma_f32_32x32x16_bf16 v[80:95], v[10:13], v[208:211], 0
  ds_read_b64_tr_b16 v[26:27], v41 offset:32896
  ds_read_b64_tr_b16 v[28:29], v41 offset:33664
  s_waitcnt lgkmcnt(6)
  v_mfma_f32_32x32x16_bf16 v[80:95], v[14:17], v[212:215], v[80:95]
  ds_read_b64_tr_b16 v[10:11], v41 offset:35968
  ds_read_b64_tr_b16 v[12:13], v41 offset:36736
  s_waitcnt lgkmcnt(6)
  v_mfma_f32_32x32x16_bf16 v[80:95], v[18:21], v[216:219], v[80:95]
  ds_read_b64_tr_b16 v[14:15], v41 offset:39040
  ds_read_b64_tr_b16 v[16:17], v41 offset:39808
  s_waitcnt lgkmcnt(6)
  v_mfma_f32_32x32x16_bf16 v[80:95], v[22:25], v[220:223], v[80:95]
  ds_read_b64_tr_b16 v[18:19], v41 offset:42112
  ds_read_b64_tr_b16 v[20:21], v41 offset:42880
  s_waitcnt lgkmcnt(6)
  v_mfma_f32_32x32x16_bf16 v[80:95], v[26:29], v[224:227], v[80:95]
  ds_read_b64_tr_b16 v[22:23], v41 offset:45184
  ds_read_b64_tr_b16 v[24:25], v41 offset:45952
  v_mov_b32 v3, 156728
  s_mov_b32 s37, 0
lw_67:
  ds_read_b32 v8, v3
  s_waitcnt lgkmcnt(0)
  v_cmp_gt_u32 vcc, 16, v8
  s_cbranch_vccz lwd_68
  s_add_u32 s37, s37, 1
  s_cmp_lt_u32 s37, 640000
  s_cbranch_scc0 lwd_68
  s_sleep 1
  s_branch lw_67
lwd_68:
  v_mov_b32 v3, 156740
  s_mov_b32 s37, 0
lw_69:
  ds_read_b32 v8, v3
  s_waitcnt lgkmcnt(0)
  v_cmp_gt_u32 vcc, 4, v8
  s_cbranch_vccz lwd_70
  s_add_u32 s37, s37, 1
  s_cmp_lt_u32 s37, 640000
  s_cbranch_scc0 lwd_70
  s_sleep 1
  s_branch lw_69
lwd_70:
  ds_read_b64 v[42:43], v45
  v_min_u32 v30, 47, v2
  v_lshlrev_b32 v30, 3, v30
  v_add_u32 v31, 158336, v30
  ds_read_b64 v[208:209], v31 offset:0
  ds_read_b64 v[210:211], v31 offset:384
  ds_read_b64 v[212:213], v31 offset:768
  ds_read_b64 v[214:215], v31 offset:1152
  s_mul_i32 s37, s35, 384
  s_add_u32 s37, s37, 159872
  s_waitcnt lgkmcnt(11)
  v_mfma_f32_32x32x16_bf16 v[80:95], v[10:13], v[228:231], v[80:95]
  ds_read_b64_tr_b16 v[26:27], v41 offset:48256
  ds_read_b64_tr_b16 v[28:29], v41 offset:49024
  v_add_u32 v30, s37, v30
  s_waitcnt lgkmcnt(2)
  v_add_f32 v208, v208, v210
  v_add_f32 v209, v209, v211
  v_add_f32 v212, v212, v214
  v_add_f32 v213, v213, v215
  v_add_f32 v208, v208, v212
  v_add_f32 v209, v209, v213
  ds_write_b64 v30, v[208:209]
  s_waitcnt lgkmcnt(0)
  s_waitcnt lgkmcnt(12)
  v_mfma_f32_32x32x16_bf16 v[80:95], v[14:17], v[232:235], v[80:95]
  ds_read_b64_tr_b16 v[10:11], v41 offset:51328
  ds_read_b64_tr_b16 v[12:13], v41 offset:52096
  ds_read_b128 v[208:211], v34 offset:0
  ds_read_b128 v[212:215], v35 offset:0
  ds_read_b128 v[216:219], v34 offset:64
  ds_read_b128 v[220:223], v35 offset:64
  s_waitcnt lgkmcnt(2)
  v_fma_f32 v212, v42, v208, v212
  v_fma_f32 v213, v42, v209, v213
  v_fma_f32 v214, v42, v210, v214
  v_fma_f32 v215, v42, v211, v215
  v_fma_f32 v48, v48, v43, v212
  s_waitcnt lgkmcnt(15)
  v_mfma_f32_32x32x16_bf16 v[80:95], v[18:21], v[236:239], v[80:95]
  ds_read_b64_tr_b16 v[14:15], v41 offset:54400
  ds_read_b64_tr_b16 v[16:17], v41 offset:55168
  v_fma_f32 v49, v49, v43, v213
  v_fma_f32 v50, v50, v43, v214
  v_fma_f32 v51, v51, v43, v215
  ds_read_b128 v[208:211], v34 offset:32
  ds_read_b128 v[212:215], v35 offset:32
  v_mul_f32 v30, v48, v48
  v_mul_f32 v31, v49, v49
  v_mul_f32 v32, v50, v50
  v_mul_f32 v33, v51, v51
  v_fma_f32 v30, v30, s51, v40
  s_waitcnt lgkmcnt(15)
  v_mfma_f32_32x32x16_bf16 v[80:95], v[22:25], v[240:243], v[80:95]
  ds_read_b64_tr_b16 v[18:19], v47 offset:128
  ds_read_b64_tr_b16 v[20:21], v47 offset:896
  v_fma_f32 v31, v31, s51, v40
  v_fma_f32 v32, v32, s51, v40
  v_fma_f32 v33, v33, s51, v40
  v_mul_f32 v30, v30, v48
  v_mul_f32 v31, v31, v49
  v_mul_f32 v32, v32, v50
  v_mul_f32 v33, v33, v51
  v_exp_f32 v30, v30
  v_exp_f32 v31, v31
  v_exp_f32 v32, v32
  s_waitcnt lgkmcnt(13)
  v_mfma_f32_32x32x16_bf16 v[80:95], v[26:29], v[244:247], v[80:95]
  ds_read_b64_tr_b16 v[22:23], v47 offset:3200
  ds_read_b64_tr_b16 v[24:25], v47 offset:3968
  v_exp_f32 v33, v33
  v_add_f32 v30, 1.0, v30
  v_add_f32 v31, 1.0, v31
  v_add_f32 v32, 1.0, v32
  v_add_f32 v33, 1.0, v33
  v_rcp_f32 v30, v30
  v_rcp_f32 v31, v31
  v_rcp_f32 v32, v32
  v_rcp_f32 v33, v33
  v_mul_f32 v48, v48, v30
  s_waitcnt lgkmcnt(12)
  v_mfma_f32_32x32x16_bf16 v[80:95], v[10:13], v[248:251], v[80:95]
  ds_read_b64_tr_b16 v[26:27], v47 offset:6272
  ds_read_b64_tr_b16 v[28:29], v47 offset:7040
  v_mul_f32 v49, v49, v31
  v_mul_f32 v50, v50, v32
  v_mul_f32 v51, v51, v33
  v_cvt_pk_bf16_f32 v48, v48, v49
  v_cvt_pk_bf16_f32 v49, v50, v51
  s_waitcnt lgkmcnt(10)
  v_fma_f32 v220, v42, v216, v220
  v_fma_f32 v221, v42, v217, v221
  v_fma_f32 v222, v42, v218, v222
  v_fma_f32 v223, v42, v219, v223
  s_waitcnt lgkmcnt(8)
  v_mfma_f32_32x32x16_bf16 v[80:95], v[14:17], v[252:255], v[80:95]
  ds_read_b64_tr_b16 v[10:11], v47 offset:9344
  ds_read_b64_tr_b16 v[12:13], v47 offset:10112
  v_fma_f32 v56, v56, v43, v220
  v_fma_f32 v57, v57, v43, v221
  v_fma_f32 v58, v58, v43, v222
  v_fma_f32 v59, v59, v43, v223
  ds_read_b128 v[216:219], v34 offset:96
  ds_read_b128 v[220:223], v35 offset:96
  v_mul_f32 v30, v56, v56
  v_mul_f32 v31, v57, v57
  v_mul_f32 v32, v58, v58
  v_mul_f32 v33, v59, v59
  s_waitcnt lgkmcnt(8)
  v_mfma_f32_32x32x16_bf16 v[80:95], v[18:21], v[96:99], v[80:95]
  ds_read_b64_tr_b16 v[14:15], v47 offset:12416
  ds_read_b64_tr_b16 v[16:17], v47 offset:13184
  v_mov_b32 v3, 156732
  v_mov_b32 v8, 1
  s_mov_b64 exec, 1
  ds_add_u32 v3, v8
  s_mov_b64 exec, -1
  v_fma_f32 v30, v30, s51, v40
  v_fma_f32 v31, v31, s51, v40
  v_fma_f32 v32, v32, s51, v40
  v_fma_f32 v33, v33, s51, v40
  v_mul_f32 v30, v30, v56
  v_mul_f32 v31, v31, v57
  v_mul_f32 v32, v32, v58
  v_mul_f32 v33, v33, v59
  v_exp_f32 v30, v30
  v_exp_f32 v31, v31
  s_waitcnt lgkmcnt(8)
  v_mfma_f32_32x32x16_bf16 v[80:95], v[22:25], v[100:103], v[80:95]
  ds_read_b64_tr_b16 v[18:19], v47 offset:15488
  ds_read_b64_tr_b16 v[20:21], v47 offset:16256
  v_exp_f32 v32, v32
  v_exp_f32 v33, v33
  v_add_f32 v30, 1.0, v30
  v_add_f32 v31, 1.0, v31
  v_add_f32 v32, 1.0, v32
  v_add_f32 v33, 1.0, v33
  v_rcp_f32 v30, v30
  v_rcp_f32 v31, v31
  v_rcp_f32 v32, v32
  v_rcp_f32 v33, v33
  s_waitcnt lgkmcnt(8)
  v_mfma_f32_32x32x16_bf16 v[80:95], v[26:29], v[104:107], v[80:95]
  ds_read_b64_tr_b16 v[22:23], v47 offset:18560
  ds_read_b64_tr_b16 v[24:25], v47 offset:19328
  v_mul_f32 v56, v56, v30
  v_mul_f32 v57, v57, v31
  v_mul_f32 v58, v58, v32
  v_mul_f32 v59, v59, v33
  v_cvt_pk_bf16_f32 v50, v56, v57
  v_cvt_pk_bf16_f32 v51, v58, v59
  s_waitcnt lgkmcnt(15)
  v_fma_f32 v212, v42, v208, v212
  v_fma_f32 v213, v42, v209, v213
  v_fma_f32 v214, v42, v210, v214
  s_waitcnt lgkmcnt(8)
  v_mfma_f32_32x32x16_bf16 v[80:95], v[10:13], v[108:111], v[80:95]
  ds_read_b64_tr_b16 v[26:27], v47 offset:21632
  ds_read_b64_tr_b16 v[28:29], v47 offset:22400
  v_fma_f32 v215, v42, v211, v215
  v_fma_f32 v52, v52, v43, v212
  v_fma_f32 v53, v53, v43, v213
  v_fma_f32 v54, v54, v43, v214
  v_fma_f32 v55, v55, v43, v215
  v_mul_f32 v30, v52, v52
  v_mul_f32 v31, v53, v53
  v_mul_f32 v32, v54, v54
  v_mul_f32 v33, v55, v55
  v_fma_f32 v30, v30, s51, v40
  s_waitcnt lgkmcnt(6)
  v_mfma_f32_32x32x16_bf16 v[80:95], v[14:17], v[112:115], v[80:95]
  ds_read_b64_tr_b16 v[10:11], v46 offset:128
  ds_read_b64_tr_b16 v[12:13], v46 offset:896
  v_fma_f32 v31, v31, s51, v40
  v_fma_f32 v32, v32, s51, v40
  v_fma_f32 v33, v33, s51, v40
  v_mul_f32 v30, v30, v52
  v_mul_f32 v31, v31, v53
  v_mul_f32 v32, v32, v54
  v_mul_f32 v33, v33, v55
  v_exp_f32 v30, v30
  v_exp_f32 v31, v31
  v_exp_f32 v32, v32
  s_waitcnt lgkmcnt(6)
  v_mfma_f32_32x32x16_bf16 v[80:95], v[18:21], v[116:119], v[80:95]
  ds_read_b64_tr_b16 v[14:15], v46 offset:3200
  ds_read_b64_tr_b16 v[16:17], v46 offset:3968
  v_exp_f32 v33, v33
  v_add_f32 v30, 1.0, v30
  v_add_f32 v31, 1.0, v31
  v_add_f32 v32, 1.0, v32
  v_add_f32 v33, 1.0, v33
  v_rcp_f32 v30, v30
  v_rcp_f32 v31, v31
  v_rcp_f32 v32, v32
  v_rcp_f32 v33, v33
  v_mul_f32 v52, v52, v30
  s_waitcnt lgkmcnt(6)
  v_mfma_f32_32x32x16_bf16 v[80:95], v[22:25], v[120:123], v[80:95]
  ds_read_b64_tr_b16 v[18:19], v46 offset:6272
  ds_read_b64_tr_b16 v[20:21], v46 offset:7040
  v_mul_f32 v53, v53, v31
  v_mul_f32 v54, v54, v32
  v_mul_f32 v55, v55, v33
  v_cvt_pk_bf16_f32 v52, v52, v53
  v_cvt_pk_bf16_f32 v53, v54, v55
  s_waitcnt lgkmcnt(14)
  v_fma_f32 v220, v42, v216, v220
  v_fma_f32 v221, v42, v217, v221
  v_fma_f32 v222, v42, v218, v222
  v_fma_f32 v223, v42, v219, v223
  s_waitcnt lgkmcnt(6)
  v_mfma_f32_32x32x16_bf16 v[80:95], v[26:29], v[124:127], v[80:95]
  ds_read_b64_tr_b16 v[22:23], v46 offset:9344
  ds_read_b64_tr_b16 v[24:25], v46 offset:10112
  v_fma_f32 v60, v60, v43, v220
  v_fma_f32 v61, v61, v43, v221
  v_fma_f32 v62, v62, v43, v222
  v_fma_f32 v63, v63, v43, v223
  v_mul_f32 v30, v60, v60
  v_mul_f32 v31, v61, v61
  v_mul_f32 v32, v62, v62
  v_mul_f32 v33, v63, v63
  v_fma_f32 v30, v30, s51, v40
  v_fma_f32 v31, v31, s51, v40
  s_waitcnt lgkmcnt(6)
  v_mfma_f32_32x32x16_bf16 v[80:95], v[10:13], v[128:131], v[80:95]
  ds_read_b64_tr_b16 v[26:27], v46 offset:12416
  ds_read_b64_tr_b16 v[28:29], v46 offset:13184
  v_fma_f32 v32, v32, s51, v40
  v_fma_f32 v33, v33, s51, v40
  v_mul_f32 v30, v30, v60
  v_mul_f32 v31, v31, v61
  v_mul_f32 v32, v32, v62
  v_mul_f32 v33, v33, v63
  v_exp_f32 v30, v30
  v_exp_f32 v31, v31
  v_exp_f32 v32, v32
  v_exp_f32 v33, v33
  s_waitcnt lgkmcnt(6)
  v_mfma_f32_32x32x16_bf16 v[80:95], v[14:17], v[132:135], v[80:95]
  ds_read_b64_tr_b16 v[10:11], v46 offset:15488
  ds_read_b64_tr_b16 v[12:13], v46 offset:16256
  v_add_f32 v30, 1.0, v30
  v_add_f32 v31, 1.0, v31
  v_add_f32 v32, 1.0, v32
  v_add_f32 v33, 1.0, v33
  v_rcp_f32 v30, v30
  v_rcp_f32 v31, v31
  v_rcp_f32 v32, v32
  v_rcp_f32 v33, v33
  v_mul_f32 v60, v60, v30
  v_mul_f32 v61, v61, v31
  s_waitcnt lgkmcnt(6)
  v_mfma_f32_32x32x16_bf16 v[80:95], v[18:21], v[136:139], v[80:95]
  ds_read_b64_tr_b16 v[14:15], v46 offset:18560
  ds_read_b64_tr_b16 v[16:17], v46 offset:19328
  v_mul_f32 v62, v62, v32
  v_mul_f32 v63, v63, v33
  v_cvt_pk_bf16_f32 v54, v60, v61
  v_cvt_pk_bf16_f32 v55, v62, v63
  s_add_u32 s46, s47, 0
  buffer_store_dwordx4 v[48:51], v44, s[24:27], s46 offen sc1
  buffer_store_dwordx4 v[52:55], v44, s[24:27], s46 offen offset:512 sc1
  ds_read_b128 v[208:211], v34 offset:128
  ds_read_b128 v[212:215], v35 offset:128
  ds_read_b128 v[216:219], v34 offset:192
  s_waitcnt lgkmcnt(9)
  v_mfma_f32_32x32x16_bf16 v[80:95], v[22:25], v[140:143], v[80:95]
  ds_read_b64_tr_b16 v[18:19], v46 offset:21632
  ds_read_b64_tr_b16 v[20:21], v46 offset:22400
  ds_read_b128 v[220:223], v35 offset:192
  s_waitcnt lgkmcnt(4)
  v_fma_f32 v212, v42, v208, v212
  v_fma_f32 v213, v42, v209, v213
  v_fma_f32 v214, v42, v210, v214
  v_fma_f32 v215, v42, v211, v215
  v_fma_f32 v64, v64, v43, v212
  v_fma_f32 v65, v65, v43, v213
  v_fma_f32 v66, v66, v43, v214
  v_fma_f32 v67, v67, v43, v215
  s_waitcnt lgkmcnt(10)
  v_mfma_f32_32x32x16_bf16 v[80:95], v[26:29], v[144:147], v[80:95]
  ds_read_b64_tr_b16 v[22:23], v46 offset:24704
  ds_read_b64_tr_b16 v[24:25], v46 offset:25472
  ds_read_b128 v[208:211], v34 offset:160
  ds_read_b128 v[212:215], v35 offset:160
  v_mul_f32 v30, v64, v64
  v_mul_f32 v31, v65, v65
  v_mul_f32 v32, v66, v66
  v_mul_f32 v33, v67, v67
  v_fma_f32 v30, v30, s51, v40
  v_fma_f32 v31, v31, s51, v40
  v_fma_f32 v32, v32, s51, v40
  v_fma_f32 v33, v33, s51, v40
  s_waitcnt lgkmcnt(12)
  v_mfma_f32_32x32x16_bf16 v[80:95], v[10:13], v[148:151], v[80:95]
  ds_read_b64_tr_b16 v[26:27], v46 offset:27776
  ds_read_b64_tr_b16 v[28:29], v46 offset:28544
  v_mul_f32 v30, v30, v64
  v_mul_f32 v31, v31, v65
  v_mul_f32 v32, v32, v66
  v_mul_f32 v33, v33, v67
  v_exp_f32 v30, v30
  v_exp_f32 v31, v31
  v_exp_f32 v32, v32
  v_exp_f32 v33, v33
  v_add_f32 v30, 1.0, v30
  v_add_f32 v31, 1.0, v31
  s_waitcnt lgkmcnt(12)
  v_mfma_f32_32x32x16_bf16 v[80:95], v[14:17], v[152:155], v[80:95]
  ds_read_b64_tr_b16 v[10:11], v46 offset:30848
  ds_read_b64_tr_b16 v[12:13], v46 offset:31616
  v_add_f32 v32, 1.0, v32
  v_add_f32 v33, 1.0, v33
  v_rcp_f32 v30, v30
  v_rcp_f32 v31, v31
  v_rcp_f32 v32, v32
  v_rcp_f32 v33, v33
  v_mul_f32 v64, v64, v30
  v_mul_f32 v65, v65, v31
  v_mul_f32 v66, v66, v32
  v_mul_f32 v67, v67, v33
  s_waitcnt lgkmcnt(9)
  v_mfma_f32_32x32x16_bf16 v[80:95], v[18:21], v[156:159], v[80:95]
  ds_read_b64_tr_b16 v[14:15], v46 offset:33920
  ds_read_b64_tr_b16 v[16:17], v46 offset:34688
  v_cvt_pk_bf16_f32 v64, v64, v65
  v_cvt_pk_bf16_f32 v65, v66, v67
  s_waitcnt lgkmcnt(10)
  v_fma_f32 v220, v42, v216, v220
  v_fma_f32 v221, v42, v217, v221
  v_fma_f32 v222, v42, v218, v222
  v_fma_f32 v223, v42, v219, v223
  v_fma_f32 v72, v72, v43, v220
  v_fma_f32 v73, v73, v43, v221
  v_fma_f32 v74, v74, v43, v222
  s_waitcnt lgkmcnt(8)
  v_mfma_f32_32x32x16_bf16 v[80:95], v[22:25], v[160:163], v[80:95]
  ds_read_b64_tr_b16 v[18:19], v46 offset:36992
  ds_read_b64_tr_b16 v[20:21], v46 offset:37760
  v_fma_f32 v75, v75, v43, v223
  ds_read_b128 v[216:219], v34 offset:224
  ds_read_b128 v[220:223], v35 offset:224
  v_mul_f32 v30, v72, v72
  v_mul_f32 v31, v73, v73
  v_mul_f32 v32, v74, v74
  v_mul_f32 v33, v75, v75
  v_fma_f32 v30, v30, s51, v40
  v_fma_f32 v31, v31, s51, v40
  v_fma_f32 v32, v32, s51, v40
  s_waitcnt lgkmcnt(8)
  v_mfma_f32_32x32x16_bf16 v[80:95], v[26:29], v[164:167], v[80:95]
  ds_read_b64_tr_b16 v[22:23], v46 offset:40064
  ds_read_b64_tr_b16 v[24:25], v46 offset:40832
  v_fma_f32 v33, v33, s51, v40
  v_mul_f32 v30, v30, v72
  v_mul_f32 v31, v31, v73
  v_mul_f32 v32, v32, v74
  v_mul_f32 v33, v33, v75
  v_exp_f32 v30, v30
  v_exp_f32 v31, v31
  v_exp_f32 v32, v32
  v_exp_f32 v33, v33
  v_add_f32 v30, 1.0, v30
  s_waitcnt lgkmcnt(8)
  v_mfma_f32_32x32x16_bf16 v[80:95], v[10:13], v[168:171], v[80:95]
  ds_read_b64_tr_b16 v[26:27], v46 offset:43136
  ds_read_b64_tr_b16 v[28:29], v46 offset:43904
  v_add_f32 v31, 1.0, v31
  v_add_f32 v32, 1.0, v32
  v_add_f32 v33, 1.0, v33
  v_rcp_f32 v30, v30
  v_rcp_f32 v31, v31
  v_rcp_f32 v32, v32
  v_rcp_f32 v33, v33
  v_mul_f32 v72, v72, v30
  v_mul_f32 v73, v73, v31
  v_mul_f32 v74, v74, v32
  s_waitcnt lgkmcnt(8)
  v_mfma_f32_32x32x16_bf16 v[80:95], v[14:17], v[172:175], v[80:95]
  ds_read_b64_tr_b16 v[10:11], v46 offset:46208
  ds_read_b64_tr_b16 v[12:13], v46 offset:46976
  v_mul_f32 v75, v75, v33
  v_cvt_pk_bf16_f32 v66, v72, v73
  v_cvt_pk_bf16_f32 v67, v74, v75
  s_waitcnt lgkmcnt(15)
  v_fma_f32 v212, v42, v208, v212
  v_fma_f32 v213, v42, v209, v213
  v_fma_f32 v214, v42, v210, v214
  v_fma_f32 v215, v42, v211, v215
  v_fma_f32 v68, v68, v43, v212
  v_fma_f32 v69, v69, v43, v213
  s_waitcnt lgkmcnt(8)
  v_mfma_f32_32x32x16_bf16 v[80:95], v[18:21], v[176:179], v[80:95]
  ds_read_b64_tr_b16 v[14:15], v46 offset:49280
  ds_read_b64_tr_b16 v[16:17], v46 offset:50048
  v_fma_f32 v70, v70, v43, v214
  v_fma_f32 v71, v71, v43, v215
  v_mul_f32 v30, v68, v68
  v_mul_f32 v31, v69, v69
  v_mul_f32 v32, v70, v70
  v_mul_f32 v33, v71, v71
  v_fma_f32 v30, v30, s51, v40
  v_fma_f32 v31, v31, s51, v40
  v_fma_f32 v32, v32, s51, v40
  v_fma_f32 v33, v33, s51, v40
  s_waitcnt lgkmcnt(6)
  v_mfma_f32_32x32x16_bf16 v[80:95], v[22:25], v[180:183], v[80:95]
  ds_read_b64_tr_b16 v[18:19], v46 offset:52352
  ds_read_b64_tr_b16 v[20:21], v46 offset:53120
  v_mul_f32 v30, v30, v68
  v_mul_f32 v31, v31, v69
  v_mul_f32 v32, v32, v70
  v_mul_f32 v33, v33, v71
  v_exp_f32 v30, v30
  v_exp_f32 v31, v31
  v_exp_f32 v32, v32
  v_exp_f32 v33, v33
  v_add_f32 v30, 1.0, v30
  v_add_f32 v31, 1.0, v31
  s_waitcnt lgkmcnt(6)
  v_mfma_f32_32x32x16_bf16 v[80:95], v[26:29], v[184:187], v[80:95]
  ds_read_b64_tr_b16 v[22:23], v46 offset:55424
  ds_read_b64_tr_b16 v[24:25], v46 offset:56192
  v_add_f32 v32, 1.0, v32
  v_add_f32 v33, 1.0, v33
  v_rcp_f32 v30, v30
  v_rcp_f32 v31, v31
  v_rcp_f32 v32, v32
  v_rcp_f32 v33, v33
  v_mul_f32 v68, v68, v30
  v_mul_f32 v69, v69, v31
  v_mul_f32 v70, v70, v32
  v_mul_f32 v71, v71, v33
  s_waitcnt lgkmcnt(6)
  v_mfma_f32_32x32x16_bf16 v[80:95], v[10:13], v[188:191], v[80:95]
  ds_read_b64_tr_b16 v[26:27], v46 offset:58496
  ds_read_b64_tr_b16 v[28:29], v46 offset:59264
  v_cvt_pk_bf16_f32 v68, v68, v69
  v_cvt_pk_bf16_f32 v69, v70, v71
  s_waitcnt lgkmcnt(14)
  v_fma_f32 v220, v42, v216, v220
  v_fma_f32 v221, v42, v217, v221
  v_fma_f32 v222, v42, v218, v222
  v_fma_f32 v223, v42, v219, v223
  v_fma_f32 v76, v76, v43, v220
  v_fma_f32 v77, v77, v43, v221
  v_fma_f32 v78, v78, v43, v222
  s_waitcnt lgkmcnt(6)
  v_mfma_f32_32x32x16_bf16 v[80:95], v[14:17], v[192:195], v[80:95]
  v_fma_f32 v79, v79, v43, v223
  v_mul_f32 v30, v76, v76
  v_mul_f32 v31, v77, v77
  v_mul_f32 v32, v78, v78
  v_mul_f32 v33, v79, v79
  v_fma_f32 v30, v30, s51, v40
  v_fma_f32 v31, v31, s51, v40
  v_fma_f32 v32, v32, s51, v40
  v_fma_f32 v33, v33, s51, v40
  v_mul_f32 v30, v30, v76
  s_waitcnt lgkmcnt(4)
  v_mfma_f32_32x32x16_bf16 v[80:95], v[18:21], v[196:199], v[80:95]
  v_mul_f32 v31, v31, v77
  v_mul_f32 v32, v32, v78
  v_mul_f32 v33, v33, v79
  v_exp_f32 v30, v30
  v_exp_f32 v31, v31
  v_exp_f32 v32, v32
  v_exp_f32 v33, v33
  v_add_f32 v30, 1.0, v30
  v_add_f32 v31, 1.0, v31
  v_add_f32 v32, 1.0, v32
  s_waitcnt lgkmcnt(2)
  v_mfma_f32_32x32x16_bf16 v[80:95], v[22:25], v[200:203], v[80:95]
  v_add_f32 v33, 1.0, v33
  v_rcp_f32 v30, v30
  v_rcp_f32 v31, v31
  v_rcp_f32 v32, v32
  v_rcp_f32 v33, v33
  v_mul_f32 v76, v76, v30
  v_mul_f32 v77, v77, v31
  v_mul_f32 v78, v78, v32
  v_mul_f32 v79, v79, v33
  v_cvt_pk_bf16_f32 v70, v76, v77
  s_waitcnt lgkmcnt(0)
  v_mfma_f32_32x32x16_bf16 v[80:95], v[26:29], v[204:207], v[80:95]
  v_cvt_pk_bf16_f32 v71, v78, v79
  s_add_u32 s46, s47, 4096
  buffer_store_dwordx4 v[64:67], v44, s[24:27], s46 offen sc1
  buffer_store_dwordx4 v[68:71], v44, s[24:27], s46 offen offset:512 sc1
  s_nop 6
  ds_read_b128 v[208:211], v34 offset:256
  ds_read_b128 v[212:215], v35 offset:256
  ds_read_b128 v[216:219], v34 offset:320
  ds_read_b128 v[220:223], v35 offset:320
  s_waitcnt lgkmcnt(2)
  v_fma_f32 v212, v42, v208, v212
  v_fma_f32 v213, v42, v209, v213
  v_fma_f32 v214, v42, v210, v214
  v_fma_f32 v215, v42, v211, v215
  v_fma_f32 v80, v80, v43, v212
  v_fma_f32 v81, v81, v43, v213
  v_fma_f32 v82, v82, v43, v214
  v_fma_f32 v83, v83, v43, v215
  ds_read_b128 v[208:211], v34 offset:288
  ds_read_b128 v[212:215], v35 offset:288
  v_mul_f32 v30, v80, v80
  v_mul_f32 v31, v81, v81
  v_mul_f32 v32, v82, v82
  v_mul_f32 v33, v83, v83
  v_fma_f32 v30, v30, s51, v40
  v_fma_f32 v31, v31, s51, v40
  v_fma_f32 v32, v32, s51, v40
  v_fma_f32 v33, v33, s51, v40
  v_mul_f32 v30, v30, v80
  v_mul_f32 v31, v31, v81
  v_mul_f32 v32, v32, v82
  v_mul_f32 v33, v33, v83
  v_exp_f32 v30, v30
  v_exp_f32 v31, v31
  v_exp_f32 v32, v32
  v_exp_f32 v33, v33
  v_add_f32 v30, 1.0, v30
  v_add_f32 v31, 1.0, v31
  v_add_f32 v32, 1.0, v32
  v_add_f32 v33, 1.0, v33
  v_rcp_f32 v30, v30
  v_rcp_f32 v31, v31
  v_rcp_f32 v32, v32
  v_rcp_f32 v33, v33
  v_mul_f32 v80, v80, v30
  v_mul_f32 v81, v81, v31
  v_mul_f32 v82, v82, v32
  v_mul_f32 v83, v83, v33
  v_cvt_pk_bf16_f32 v80, v80, v81
  v_cvt_pk_bf16_f32 v81, v82, v83
  s_waitcnt lgkmcnt(2)
  v_fma_f32 v220, v42, v216, v220
  v_fma_f32 v221, v42, v217, v221
  v_fma_f32 v222, v42, v218, v222
  v_fma_f32 v223, v42, v219, v223
  v_fma_f32 v88, v88, v43, v220
  v_fma_f32 v89, v89, v43, v221
  v_fma_f32 v90, v90, v43, v222
  v_fma_f32 v91, v91, v43, v223
  ds_read_b128 v[216:219], v34 offset:352
  ds_read_b128 v[220:223], v35 offset:352
  v_mul_f32 v30, v88, v88
  v_mul_f32 v31, v89, v89
  v_mul_f32 v32, v90, v90
  v_mul_f32 v33, v91, v91
  v_fma_f32 v30, v30, s51, v40
  v_fma_f32 v31, v31, s51, v40
  v_fma_f32 v32, v32, s51, v40
  v_fma_f32 v33, v33, s51, v40
  v_mul_f32 v30, v30, v88
  v_mul_f32 v31, v31, v89
  v_mul_f32 v32, v32, v90
  v_mul_f32 v33, v33, v91
  v_exp_f32 v30, v30
  v_exp_f32 v31, v31
  v_exp_f32 v32, v32
  v_exp_f32 v33, v33
  v_add_f32 v30, 1.0, v30
  v_add_f32 v31, 1.0, v31
  v_add_f32 v32, 1.0, v32
  v_add_f32 v33, 1.0, v33
  v_rcp_f32 v30, v30
  v_rcp_f32 v31, v31
  v_rcp_f32 v32, v32
  v_rcp_f32 v33, v33
  v_mul_f32 v88, v88, v30
  v_mul_f32 v89, v89, v31
  v_mul_f32 v90, v90, v32
  v_mul_f32 v91, v91, v33
  v_cvt_pk_bf16_f32 v82, v88, v89
  v_cvt_pk_bf16_f32 v83, v90, v91
  s_waitcnt lgkmcnt(2)
  v_fma_f32 v212, v42, v208, v212
  v_fma_f32 v213, v42, v209, v213
  v_fma_f32 v214, v42, v210, v214
  v_fma_f32 v215, v42, v211, v215
  v_fma_f32 v84, v84, v43, v212
  v_fma_f32 v85, v85, v43, v213
  v_fma_f32 v86, v86, v43, v214
  v_fma_f32 v87, v87, v43, v215
  v_mul_f32 v30, v84, v84
  v_mul_f32 v31, v85, v85
  v_mul_f32 v32, v86, v86
  v_mul_f32 v33, v87, v87
  v_fma_f32 v30, v30, s51, v40
  v_fma_f32 v31, v31, s51, v40
  v_fma_f32 v32, v32, s51, v40
  v_fma_f32 v33, v33, s51, v40
  v_mul_f32 v30, v30, v84
  v_mul_f32 v31, v31, v85
  v_mul_f32 v32, v32, v86
  v_mul_f32 v33, v33, v87
  v_exp_f32 v30, v30
  v_exp_f32 v31, v31
  v_exp_f32 v32, v32
  v_exp_f32 v33, v33
  v_add_f32 v30, 1.0, v30
  v_add_f32 v31, 1.0, v31
  v_add_f32 v32, 1.0, v32
  v_add_f32 v33, 1.0, v33
  v_rcp_f32 v30, v30
  v_rcp_f32 v31, v31
  v_rcp_f32 v32, v32
  v_rcp_f32 v33, v33
  v_mul_f32 v84, v84, v30
  v_mul_f32 v85, v85, v31
  v_mul_f32 v86, v86, v32
  v_mul_f32 v87, v87, v33
  v_cvt_pk_bf16_f32 v84, v84, v85
  v_cvt_pk_bf16_f32 v85, v86, v87
  s_waitcnt lgkmcnt(0)
  v_fma_f32 v220, v42, v216, v220
  v_fma_f32 v221, v42, v217, v221
  v_fma_f32 v222, v42, v218, v222
  v_fma_f32 v223, v42, v219, v223
  v_fma_f32 v92, v92, v43, v220
  v_fma_f32 v93, v93, v43, v221
  v_fma_f32 v94, v94, v43, v222
  v_fma_f32 v95, v95, v43, v223
  v_mul_f32 v30, v92, v92
  v_mul_f32 v31, v93, v93
  v_mul_f32 v32, v94, v94
  v_mul_f32 v33, v95, v95
  v_fma_f32 v30, v30, s51, v40
  v_fma_f32 v31, v31, s51, v40
  v_fma_f32 v32, v32, s51, v40
  v_fma_f32 v33, v33, s51, v40
  v_mul_f32 v30, v30, v92
  v_mul_f32 v31, v31, v93
  v_mul_f32 v32, v32, v94
  v_mul_f32 v33, v33, v95
  v_exp_f32 v30, v30
  v_exp_f32 v31, v31
  v_exp_f32 v32, v32
  v_exp_f32 v33, v33
  v_add_f32 v30, 1.0, v30
  v_add_f32 v31, 1.0, v31
  v_add_f32 v32, 1.0, v32
  v_add_f32 v33, 1.0, v33
  v_rcp_f32 v30, v30
  v_rcp_f32 v31, v31
  v_rcp_f32 v32, v32
  v_rcp_f32 v33, v33
  v_mul_f32 v92, v92, v30
  v_mul_f32 v93, v93, v31
  v_mul_f32 v94, v94, v32
  v_mul_f32 v95, v95, v33
  v_cvt_pk_bf16_f32 v86, v92, v93
  v_cvt_pk_bf16_f32 v87, v94, v95
  s_add_u32 s46, s47, 8192
  buffer_store_dwordx4 v[80:83], v44, s[24:27], s46 offen sc1
  buffer_store_dwordx4 v[84:87], v44, s[24:27], s46 offen offset:512 sc1
  s_setprio 0
  s_lshl_b32 s59, s33, 4
  s_add_u32 s59, s59, s34
  s_lshl_b32 s59, s59, 7
  s_add_u32 s59, s59, 622592
  s_and_b32 s37, s2, 7
  s_lshr_b32 s38, s2, 3
  s_lshr_b32 s33, s37, 2
  s_lshl_b32 s33, s33, 4
  s_bfe_u32 s39, s37, 0x10001
  s_lshl_b32 s39, s39, 3
  s_add_u32 s33, s33, s39
  s_and_b32 s39, s38, 7
  s_add_u32 s33, s33, s39
  s_and_b32 s34, s37, 1
  s_lshl_b32 s34, s34, 2
  s_lshr_b32 s39, s38, 3
  s_add_u32 s34, s34, s39
  s_add_u32 s8, s80, 720896
  s_addc_u32 s9, s81, 0
  s_mov_b32 s10, 2785280
  s_mov_b32 s11, 0x20000
  s_mov_b32 s12, s74
  s_mov_b32 s13, s75
  s_mov_b32 s14, 1280
  s_mov_b32 s15, 0x20000
  s_mov_b32 s20, s76
  s_mov_b32 s21, s77
  s_mov_b32 s22, 2621440
  s_mov_b32 s23, 0x20000
  v_lshrrev_b32 v3, 1, v2
  v_min_u32 v3, 16, v3
  s_mul_i32 s37, s35, 12
  s_mul_i32 s38, s35, 5
  s_add_u32 s38, s38, 36
  v_add_u32 v4, s37, v3
  v_add_u32 v5, s38, v3
  v_cmp_gt_u32 vcc, 12, v3
  s_nop 1
  v_cndmask_b32 v4, v5, v4, vcc
  s_mul_i32 s37, s34, 5
  s_lshr_b32 s38, s37, 2
  s_add_u32 s37, s37, 4
  s_lshr_b32 s39, s37, 2
  v_and_b32 v5, 1, v2
  v_mov_b32 v6, s38
  v_mov_b32 v7, s39
  v_cmp_eq_u32 vcc, 0, v5
  s_nop 1
  v_cndmask_b32 v6, v7, v6, vcc
  v_mul_u32_u24 v4, 10, v4
  v_add_u32 v4, v4, v6
  v_mul_u32_u24 v4, 683, v4
  v_lshrrev_b32 v4, 11, v4
  v_lshlrev_b32 v4, 7, v4
  v_add_u32 v4, 688128, v4
  buffer_load_dword v8, v4, s[16:19], 0 offen sc1
  v_mov_b32 v9, v4
  v_lshlrev_b32 v3, 4, v2
  v_add_u32 v4, 4096, v3
  v_and_b32 v5, 15, v2
  s_lshl_b32 s39, s33, 6
  s_lshl_b32 s40, s35, 4
  s_add_u32 s39, s39, s40
  v_add_u32 v5, s39, v5
  v_mul_u32_u24 v5, 1280, v5
  v_lshrrev_b32 v6, 4, v2
  v_lshlrev_b32 v6, 3, v6
  s_mul_i32 s39, s34, 160
  v_add_u32 v6, s39, v6
  v_add_u32 v5, v5, v6
  s_mul_i32 s40, s33, 278528
  s_mul_i32 s41, s34, 348160
  s_mul_i32 s42, s35, 12
  s_mul_i32 s43, s35, 5
  s_add_u32 s43, s43, 48
  s_lshl_b32 s44, s42, 12
  s_add_u32 s44, s44, s40
  s_mul_i32 s45, s42, 5120
  s_add_u32 s45, s45, s41
  s_lshl_b32 s46, s43, 12
  s_add_u32 s46, s46, s40
  s_mul_i32 s47, s43, 5120
  s_add_u32 s47, s47, s41
  s_waitcnt vmcnt(1)
  s_waitcnt vmcnt(0)
  v_mov_b32 v7, 156712
  v_mov_b32 v207, 1
  s_mov_b64 exec, 1
  ds_add_rtn_u32 v207, v7, v207
  s_waitcnt lgkmcnt(0)
  s_mov_b64 exec, -1
  v_readfirstlane_b32 s37, v207
  s_nop 3
  s_cmp_eq_u32 s37, 3
  s_cbranch_scc0 ag_71
  v_mov_b32 v7, s82
  v_mov_b32 v207, 0
  s_mov_b64 exec, 1
  buffer_store_dword v7, v207, s[16:19], s59 offen sc1
  s_mov_b64 exec, -1
ag_71:
  v_cmp_ne_u32 vcc, s82, v8
  s_cbranch_vccz cpd_73
  s_mov_b32 s37, 0
cp_72:
  buffer_load_dword v8, v9, s[16:19], 0 offen sc1
  s_waitcnt vmcnt(0)
  v_cmp_ne_u32 vcc, s82, v8
  s_cbranch_vccz cpd_73
  s_add_u32 s37, s37, 1
  s_cmp_lt_u32 s37, 20000
  s_cbranch_scc0 cpd_73
  s_sleep 4
  s_branch cp_72
cpd_73:
  buffer_load_dwordx2 v[90:91], v5, s[4:7], 0 offen offset:0
  buffer_load_dwordx2 v[92:93], v5, s[4:7], 0 offen offset:32
  buffer_load_dwordx2 v[94:95], v5, s[4:7], 0 offen offset:64
  buffer_load_dwordx2 v[96:97], v5, s[4:7], 0 offen offset:96
  buffer_load_dwordx2 v[98:99], v5, s[4:7], 0 offen offset:128
  s_add_u32 s57, s45, 0
  buffer_load_dwordx4 v[100:103], v3, s[8:11], s57 offen offset:0 sc1
  buffer_load_dwordx4 v[104:107], v3, s[8:11], s57 offen offset:1024 sc1
  buffer_load_dwordx4 v[108:111], v3, s[8:11], s57 offen offset:2048 sc1
  buffer_load_dwordx4 v[112:115], v3, s[8:11], s57 offen offset:3072 sc1
  buffer_load_dwordx4 v[116:119], v4, s[8:11], s57 offen sc1
  s_add_u32 s57, s45, 5120
  buffer_load_dwordx4 v[120:123], v3, s[8:11], s57 offen offset:0 sc1
  buffer_load_dwordx4 v[124:127], v3, s[8:11], s57 offen offset:1024 sc1
  buffer_load_dwordx4 v[128:131], v3, s[8:11], s57 offen offset:2048 sc1
  buffer_load_dwordx4 v[132:135], v3, s[8:11], s57 offen offset:3072 sc1
  buffer_load_dwordx4 v[136:139], v4, s[8:11], s57 offen sc1
  s_add_u32 s57, s45, 10240
  buffer_load_dwordx4 v[140:143], v3, s[8:11], s57 offen offset:0 sc1
  buffer_load_dwordx4 v[144:147], v3, s[8:11], s57 offen offset:1024 sc1
  buffer_load_dwordx4 v[148:151], v3, s[8:11], s57 offen offset:2048 sc1
  buffer_load_dwordx4 v[152:155], v3, s[8:11], s57 offen offset:3072 sc1
  buffer_load_dwordx4 v[156:159], v4, s[8:11], s57 offen sc1
  s_add_u32 s57, s45, 15360
  buffer_load_dwordx4 v[160:163], v3, s[8:11], s57 offen offset:0 sc1
  buffer_load_dwordx4 v[164:167], v3, s[8:11], s57 offen offset:1024 sc1
  buffer_load_dwordx4 v[168:171], v3, s[8:11], s57 offen offset:2048 sc1
  buffer_load_dwordx4 v[172:175], v3, s[8:11], s57 offen offset:3072 sc1
  buffer_load_dwordx4 v[176:179], v4, s[8:11], s57 offen sc1
  s_add_u32 s57, s45, 20480
  buffer_load_dwordx4 v[180:183], v3, s[8:11], s57 offen offset:0 sc1
  buffer_load_dwordx4 v[184:187], v3, s[8:11], s57 offen offset:1024 sc1
  buffer_load_dwordx4 v[188:191], v3, s[8:11], s57 offen offset:2048 sc1
  buffer_load_dwordx4 v[192:195], v3, s[8:11], s57 offen offset:3072 sc1
  buffer_load_dwordx4 v[196:199], v4, s[8:11], s57 offen sc1
  v_and_b32 v7, 3, v2
  s_lshl_b32 s37, s35, 2
  v_add_u32 v7, s37, v7
  s_lshr_b32 s37, s33, 1
  s_lshl_b32 s37, s37, 4
  v_add_u32 v7, s37, v7
  v_lshlrev_b32 v7, 7, v7
  v_add_u32 v7, 622592, v7
  s_mov_b32 s37, 0
poll_74:
  buffer_load_dword v8, v7, s[16:19], 0 offen sc1
  s_waitcnt vmcnt(0)
  v_cmp_ne_u32 vcc, s82, v8
  s_cbranch_vccz polld_75
  s_add_u32 s37, s37, 1
  s_cmp_lt_u32 s37, 20000
  s_cbranch_scc0 polld_75
  s_sleep 4
  s_branch poll_74
polld_75:
  v_and_b32 v7, 3, v2
  s_lshl_b32 s37, s35, 2
  v_add_u32 v7, s37, v7
  s_lshr_b32 s37, s33, 1
  s_lshl_b32 s37, s37, 4
  v_add_u32 v7, s37, v7
  v_lshlrev_b32 v7, 7, v7
  v_add_u32 v7, 655360, v7
  s_add_u32 s56, s44, 0
  buffer_load_dwordx4 v[200:203], v3, s[24:27], s56 offen offset:0 sc1
  buffer_load_dwordx4 v[204:207], v3, s[24:27], s56 offen offset:1024 sc1
  buffer_load_dwordx4 v[208:211], v3, s[24:27], s56 offen offset:2048 sc1
  buffer_load_dwordx4 v[212:215], v3, s[24:27], s56 offen offset:3072 sc1
  s_add_u32 s56, s44, 4096
  buffer_load_dwordx4 v[216:219], v3, s[24:27], s56 offen offset:0 sc1
  buffer_load_dwordx4 v[220:223], v3, s[24:27], s56 offen offset:1024 sc1
  buffer_load_dwordx4 v[224:227], v3, s[24:27], s56 offen offset:2048 sc1
  buffer_load_dwordx4 v[228:231], v3, s[24:27], s56 offen offset:3072 sc1
  s_add_u32 s56, s44, 8192
  buffer_load_dwordx4 v[232:235], v3, s[24:27], s56 offen offset:0 sc1
  buffer_load_dwordx4 v[236:239], v3, s[24:27], s56 offen offset:1024 sc1
  buffer_load_dwordx4 v[240:243], v3, s[24:27], s56 offen offset:2048 sc1
  buffer_load_dwordx4 v[244:247], v3, s[24:27], s56 offen offset:3072 sc1
  s_waitcnt vmcnt(8)
  s_waitcnt vmcnt(32)
  v_mfma_f32_16x16x32_bf16 v[10:13], v[100:103], v[200:203], 0
  v_mfma_f32_16x16x32_bf16 v[14:17], v[100:103], v[204:207], 0
  v_mfma_f32_16x16x32_bf16 v[18:21], v[100:103], v[208:211], 0
  v_mfma_f32_16x16x32_bf16 v[22:25], v[100:103], v[212:215], 0
  v_mfma_f32_16x16x32_bf16 v[26:29], v[104:107], v[200:203], 0
  v_mfma_f32_16x16x32_bf16 v[30:33], v[104:107], v[204:207], 0
  v_mfma_f32_16x16x32_bf16 v[34:37], v[104:107], v[208:211], 0
  v_mfma_f32_16x16x32_bf16 v[38:41], v[104:107], v[212:215], 0
  v_mfma_f32_16x16x32_bf16 v[42:45], v[108:111], v[200:203], 0
  v_mfma_f32_16x16x32_bf16 v[46:49], v[108:111], v[204:207], 0
  v_mfma_f32_16x16x32_bf16 v[50:53], v[108:111], v[208:211], 0
  v_mfma_f32_16x16x32_bf16 v[54:57], v[108:111], v[212:215], 0
  v_mfma_f32_16x16x32_bf16 v[58:61], v[112:115], v[200:203], 0
  v_mfma_f32_16x16x32_bf16 v[62:65], v[112:115], v[204:207], 0
  v_mfma_f32_16x16x32_bf16 v[66:69], v[112:115], v[208:211], 0
  v_mfma_f32_16x16x32_bf16 v[70:73], v[112:115], v[212:215], 0
  v_mfma_f32_16x16x32_bf16 v[74:77], v[116:119], v[200:203], 0
  v_mfma_f32_16x16x32_bf16 v[78:81], v[116:119], v[204:207], 0
  v_mfma_f32_16x16x32_bf16 v[82:85], v[116:119], v[208:211], 0
  v_mfma_f32_16x16x32_bf16 v[86:89], v[116:119], v[212:215], 0
  s_add_u32 s56, s44, 12288
  buffer_load_dwordx4 v[200:203], v3, s[24:27], s56 offen offset:0 sc1
  buffer_load_dwordx4 v[204:207], v3, s[24:27], s56 offen offset:1024 sc1
  buffer_load_dwordx4 v[208:211], v3, s[24:27], s56 offen offset:2048 sc1
  buffer_load_dwordx4 v[212:215], v3, s[24:27], s56 offen offset:3072 sc1
  s_add_u32 s57, s45, 25600
  buffer_load_dwordx4 v[100:103], v3, s[8:11], s57 offen offset:0 sc1
  buffer_load_dwordx4 v[104:107], v3, s[8:11], s57 offen offset:1024 sc1
  buffer_load_dwordx4 v[108:111], v3, s[8:11], s57 offen offset:2048 sc1
  buffer_load_dwordx4 v[112:115], v3, s[8:11], s57 offen offset:3072 sc1
  buffer_load_dwordx4 v[116:119], v4, s[8:11], s57 offen sc1
  s_waitcnt vmcnt(13)
  s_waitcnt vmcnt(36)
  v_mfma_f32_16x16x32_bf16 v[10:13], v[120:123], v[216:219], v[10:13]
  v_mfma_f32_16x16x32_bf16 v[14:17], v[120:123], v[220:223], v[14:17]
  v_mfma_f32_16x16x32_bf16 v[18:21], v[120:123], v[224:227], v[18:21]
  v_mfma_f32_16x16x32_bf16 v[22:25], v[120:123], v[228:231], v[22:25]
  v_mfma_f32_16x16x32_bf16 v[26:29], v[124:127], v[216:219], v[26:29]
  v_mfma_f32_16x16x32_bf16 v[30:33], v[124:127], v[220:223], v[30:33]
  v_mfma_f32_16x16x32_bf16 v[34:37], v[124:127], v[224:227], v[34:37]
  v_mfma_f32_16x16x32_bf16 v[38:41], v[124:127], v[228:231], v[38:41]
  v_mfma_f32_16x16x32_bf16 v[42:45], v[128:131], v[216:219], v[42:45]
  v_mfma_f32_16x16x32_bf16 v[46:49], v[128:131], v[220:223], v[46:49]
  v_mfma_f32_16x16x32_bf16 v[50:53], v[128:131], v[224:227], v[50:53]
  v_mfma_f32_16x16x32_bf16 v[54:57], v[128:131], v[228:231], v[54:57]
  v_mfma_f32_16x16x32_bf16 v[58:61], v[132:135], v[216:219], v[58:61]
  v_mfma_f32_16x16x32_bf16 v[62:65], v[132:135], v[220:223], v[62:65]
  v_mfma_f32_16x16x32_bf16 v[66:69], v[132:135], v[224:227], v[66:69]
  v_mfma_f32_16x16x32_bf16 v[70:73], v[132:135], v[228:231], v[70:73]
  v_mfma_f32_16x16x32_bf16 v[74:77], v[136:139], v[216:219], v[74:77]
  v_mfma_f32_16x16x32_bf16 v[78:81], v[136:139], v[220:223], v[78:81]
  v_mfma_f32_16x16x32_bf16 v[82:85], v[136:139], v[224:227], v[82:85]
  v_mfma_f32_16x16x32_bf16 v[86:89], v[136:139], v[228:231], v[86:89]
  s_add_u32 s56, s44, 16384
  buffer_load_dwordx4 v[216:219], v3, s[24:27], s56 offen offset:0 sc1
  buffer_load_dwordx4 v[220:223], v3, s[24:27], s56 offen offset:1024 sc1
  buffer_load_dwordx4 v[224:227], v3, s[24:27], s56 offen offset:2048 sc1
  buffer_load_dwordx4 v[228:231], v3, s[24:27], s56 offen offset:3072 sc1
  s_add_u32 s57, s45, 30720
  buffer_load_dwordx4 v[120:123], v3, s[8:11], s57 offen offset:0 sc1
  buffer_load_dwordx4 v[124:127], v3, s[8:11], s57 offen offset:1024 sc1
  buffer_load_dwordx4 v[128:131], v3, s[8:11], s57 offen offset:2048 sc1
  buffer_load_dwordx4 v[132:135], v3, s[8:11], s57 offen offset:3072 sc1
  buffer_load_dwordx4 v[136:139], v4, s[8:11], s57 offen sc1
  s_waitcnt vmcnt(18)
  s_waitcnt vmcnt(40)
  v_mfma_f32_16x16x32_bf16 v[10:13], v[140:143], v[232:235], v[10:13]
  v_mfma_f32_16x16x32_bf16 v[14:17], v[140:143], v[236:239], v[14:17]
  v_mfma_f32_16x16x32_bf16 v[18:21], v[140:143], v[240:243], v[18:21]
  v_mfma_f32_16x16x32_bf16 v[22:25], v[140:143], v[244:247], v[22:25]
  v_mfma_f32_16x16x32_bf16 v[26:29], v[144:147], v[232:235], v[26:29]
  v_mfma_f32_16x16x32_bf16 v[30:33], v[144:147], v[236:239], v[30:33]
  v_mfma_f32_16x16x32_bf16 v[34:37], v[144:147], v[240:243], v[34:37]
  v_mfma_f32_16x16x32_bf16 v[38:41], v[144:147], v[244:247], v[38:41]
  v_mfma_f32_16x16x32_bf16 v[42:45], v[148:151], v[232:235], v[42:45]
  v_mfma_f32_16x16x32_bf16 v[46:49], v[148:151], v[236:239], v[46:49]
  v_mfma_f32_16x16x32_bf16 v[50:53], v[148:151], v[240:243], v[50:53]
  v_mfma_f32_16x16x32_bf16 v[54:57], v[148:151], v[244:247], v[54:57]
  v_mfma_f32_16x16x32_bf16 v[58:61], v[152:155], v[232:235], v[58:61]
  v_mfma_f32_16x16x32_bf16 v[62:65], v[152:155], v[236:239], v[62:65]
  v_mfma_f32_16x16x32_bf16 v[66:69], v[152:155], v[240:243], v[66:69]
  v_mfma_f32_16x16x32_bf16 v[70:73], v[152:155], v[244:247], v[70:73]
  v_mfma_f32_16x16x32_bf16 v[74:77], v[156:159], v[232:235], v[74:77]
  v_mfma_f32_16x16x32_bf16 v[78:81], v[156:159], v[236:239], v[78:81]
  v_mfma_f32_16x16x32_bf16 v[82:85], v[156:159], v[240:243], v[82:85]
  v_mfma_f32_16x16x32_bf16 v[86:89], v[156:159], v[244:247], v[86:89]
  s_add_u32 s56, s44, 20480
  buffer_load_dwordx4 v[232:235], v3, s[24:27], s56 offen offset:0 sc1
  buffer_load_dwordx4 v[236:239], v3, s[24:27], s56 offen offset:1024 sc1
  buffer_load_dwordx4 v[240:243], v3, s[24:27], s56 offen offset:2048 sc1
  buffer_load_dwordx4 v[244:247], v3, s[24:27], s56 offen offset:3072 sc1
  s_add_u32 s57, s45, 35840
  buffer_load_dwordx4 v[140:143], v3, s[8:11], s57 offen offset:0 sc1
  buffer_load_dwordx4 v[144:147], v3, s[8:11], s57 offen offset:1024 sc1
  buffer_load_dwordx4 v[148:151], v3, s[8:11], s57 offen offset:2048 sc1
  buffer_load_dwordx4 v[152:155], v3, s[8:11], s57 offen offset:3072 sc1
  buffer_load_dwordx4 v[156:159], v4, s[8:11], s57 offen sc1
  s_waitcnt vmcnt(23)
  s_waitcnt vmcnt(44)
  v_mfma_f32_16x16x32_bf16 v[10:13], v[160:163], v[200:203], v[10:13]
  v_mfma_f32_16x16x32_bf16 v[14:17], v[160:163], v[204:207], v[14:17]
  v_mfma_f32_16x16x32_bf16 v[18:21], v[160:163], v[208:211], v[18:21]
  v_mfma_f32_16x16x32_bf16 v[22:25], v[160:163], v[212:215], v[22:25]
  v_mfma_f32_16x16x32_bf16 v[26:29], v[164:167], v[200:203], v[26:29]
  v_mfma_f32_16x16x32_bf16 v[30:33], v[164:167], v[204:207], v[30:33]
  v_mfma_f32_16x16x32_bf16 v[34:37], v[164:167], v[208:211], v[34:37]
  v_mfma_f32_16x16x32_bf16 v[38:41], v[164:167], v[212:215], v[38:41]
  v_mfma_f32_16x16x32_bf16 v[42:45], v[168:171], v[200:203], v[42:45]
  v_mfma_f32_16x16x32_bf16 v[46:49], v[168:171], v[204:207], v[46:49]
  v_mfma_f32_16x16x32_bf16 v[50:53], v[168:171], v[208:211], v[50:53]
  v_mfma_f32_16x16x32_bf16 v[54:57], v[168:171], v[212:215], v[54:57]
  v_mfma_f32_16x16x32_bf16 v[58:61], v[172:175], v[200:203], v[58:61]
  v_mfma_f32_16x16x32_bf16 v[62:65], v[172:175], v[204:207], v[62:65]
  v_mfma_f32_16x16x32_bf16 v[66:69], v[172:175], v[208:211], v[66:69]
  v_mfma_f32_16x16x32_bf16 v[70:73], v[172:175], v[212:215], v[70:73]
  v_mfma_f32_16x16x32_bf16 v[74:77], v[176:179], v[200:203], v[74:77]
  v_mfma_f32_16x16x32_bf16 v[78:81], v[176:179], v[204:207], v[78:81]
  v_mfma_f32_16x16x32_bf16 v[82:85], v[176:179], v[208:211], v[82:85]
  v_mfma_f32_16x16x32_bf16 v[86:89], v[176:179], v[212:215], v[86:89]
  s_add_u32 s56, s44, 24576
  buffer_load_dwordx4 v[200:203], v3, s[24:27], s56 offen offset:0 sc1
  buffer_load_dwordx4 v[204:207], v3, s[24:27], s56 offen offset:1024 sc1
  buffer_load_dwordx4 v[208:211], v3, s[24:27], s56 offen offset:2048 sc1
  buffer_load_dwordx4 v[212:215], v3, s[24:27], s56 offen offset:3072 sc1
  s_add_u32 s57, s45, 40960
  buffer_load_dwordx4 v[160:163], v3, s[8:11], s57 offen offset:0 sc1
  buffer_load_dwordx4 v[164:167], v3, s[8:11], s57 offen offset:1024 sc1
  buffer_load_dwordx4 v[168:171], v3, s[8:11], s57 offen offset:2048 sc1
  buffer_load_dwordx4 v[172:175], v3, s[8:11], s57 offen offset:3072 sc1
  buffer_load_dwordx4 v[176:179], v4, s[8:11], s57 offen sc1
  s_waitcnt vmcnt(23)
  s_waitcnt vmcnt(48)
  v_mfma_f32_16x16x32_bf16 v[10:13], v[180:183], v[216:219], v[10:13]
  v_mfma_f32_16x16x32_bf16 v[14:17], v[180:183], v[220:223], v[14:17]
  v_mfma_f32_16x16x32_bf16 v[18:21], v[180:183], v[224:227], v[18:21]
  v_mfma_f32_16x16x32_bf16 v[22:25], v[180:183], v[228:231], v[22:25]
  v_mfma_f32_16x16x32_bf16 v[26:29], v[184:187], v[216:219], v[26:29]
  v_mfma_f32_16x16x32_bf16 v[30:33], v[184:187], v[220:223], v[30:33]
  v_mfma_f32_16x16x32_bf16 v[34:37], v[184:187], v[224:227], v[34:37]
  v_mfma_f32_16x16x32_bf16 v[38:41], v[184:187], v[228:231], v[38:41]
  v_mfma_f32_16x16x32_bf16 v[42:45], v[188:191], v[216:219], v[42:45]
  v_mfma_f32_16x16x32_bf16 v[46:49], v[188:191], v[220:223], v[46:49]
  v_mfma_f32_16x16x32_bf16 v[50:53], v[188:191], v[224:227], v[50:53]
  v_mfma_f32_16x16x32_bf16 v[54:57], v[188:191], v[228:231], v[54:57]
  v_mfma_f32_16x16x32_bf16 v[58:61], v[192:195], v[216:219], v[58:61]
  v_mfma_f32_16x16x32_bf16 v[62:65], v[192:195], v[220:223], v[62:65]
  v_mfma_f32_16x16x32_bf16 v[66:69], v[192:195], v[224:227], v[66:69]
  v_mfma_f32_16x16x32_bf16 v[70:73], v[192:195], v[228:231], v[70:73]
  v_mfma_f32_16x16x32_bf16 v[74:77], v[196:199], v[216:219], v[74:77]
  v_mfma_f32_16x16x32_bf16 v[78:81], v[196:199], v[220:223], v[78:81]
  v_mfma_f32_16x16x32_bf16 v[82:85], v[196:199], v[224:227], v[82:85]
  v_mfma_f32_16x16x32_bf16 v[86:89], v[196:199], v[228:231], v[86:89]
  s_add_u32 s56, s44, 28672
  buffer_load_dwordx4 v[216:219], v3, s[24:27], s56 offen offset:0 sc1
  buffer_load_dwordx4 v[220:223], v3, s[24:27], s56 offen offset:1024 sc1
  buffer_load_dwordx4 v[224:227], v3, s[24:27], s56 offen offset:2048 sc1
  buffer_load_dwordx4 v[228:231], v3, s[24:27], s56 offen offset:3072 sc1
  s_add_u32 s57, s45, 46080
  buffer_load_dwordx4 v[180:183], v3, s[8:11], s57 offen offset:0 sc1
  buffer_load_dwordx4 v[184:187], v3, s[8:11], s57 offen offset:1024 sc1
  buffer_load_dwordx4 v[188:191], v3, s[8:11], s57 offen offset:2048 sc1
  buffer_load_dwordx4 v[192:195], v3, s[8:11], s57 offen offset:3072 sc1
  buffer_load_dwordx4 v[196:199], v4, s[8:11], s57 offen sc1
  s_waitcnt vmcnt(23)
  s_waitcnt vmcnt(36)
  v_mfma_f32_16x16x32_bf16 v[10:13], v[100:103], v[232:235], v[10:13]
  v_mfma_f32_16x16x32_bf16 v[14:17], v[100:103], v[236:239], v[14:17]
  v_mfma_f32_16x16x32_bf16 v[18:21], v[100:103], v[240:243], v[18:21]
  v_mfma_f32_16x16x32_bf16 v[22:25], v[100:103], v[244:247], v[22:25]
  v_mfma_f32_16x16x32_bf16 v[26:29], v[104:107], v[232:235], v[26:29]
  v_mfma_f32_16x16x32_bf16 v[30:33], v[104:107], v[236:239], v[30:33]
  v_mfma_f32_16x16x32_bf16 v[34:37], v[104:107], v[240:243], v[34:37]
  v_mfma_f32_16x16x32_bf16 v[38:41], v[104:107], v[244:247], v[38:41]
  v_mfma_f32_16x16x32_bf16 v[42:45], v[108:111], v[232:235], v[42:45]
  v_mfma_f32_16x16x32_bf16 v[46:49], v[108:111], v[236:239], v[46:49]
  v_mfma_f32_16x16x32_bf16 v[50:53], v[108:111], v[240:243], v[50:53]
  v_mfma_f32_16x16x32_bf16 v[54:57], v[108:111], v[244:247], v[54:57]
  v_mfma_f32_16x16x32_bf16 v[58:61], v[112:115], v[232:235], v[58:61]
  v_mfma_f32_16x16x32_bf16 v[62:65], v[112:115], v[236:239], v[62:65]
  v_mfma_f32_16x16x32_bf16 v[66:69], v[112:115], v[240:243], v[66:69]
  v_mfma_f32_16x16x32_bf16 v[70:73], v[112:115], v[244:247], v[70:73]
  v_mfma_f32_16x16x32_bf16 v[74:77], v[116:119], v[232:235], v[74:77]
  v_mfma_f32_16x16x32_bf16 v[78:81], v[116:119], v[236:239], v[78:81]
  v_mfma_f32_16x16x32_bf16 v[82:85], v[116:119], v[240:243], v[82:85]
  v_mfma_f32_16x16x32_bf16 v[86:89], v[116:119], v[244:247], v[86:89]
  s_add_u32 s56, s44, 32768
  buffer_load_dwordx4 v[232:235], v3, s[24:27], s56 offen offset:0 sc1
  buffer_load_dwordx4 v[236:239], v3, s[24:27], s56 offen offset:1024 sc1
  buffer_load_dwordx4 v[240:243], v3, s[24:27], s56 offen offset:2048 sc1
  buffer_load_dwordx4 v[244:247], v3, s[24:27], s56 offen offset:3072 sc1
  s_add_u32 s57, s45, 51200
  buffer_load_dwordx4 v[100:103], v3, s[8:11], s57 offen offset:0 sc1
  buffer_load_dwordx4 v[104:107], v3, s[8:11], s57 offen offset:1024 sc1
  buffer_load_dwordx4 v[108:111], v3, s[8:11], s57 offen offset:2048 sc1
  buffer_load_dwordx4 v[112:115], v3, s[8:11], s57 offen offset:3072 sc1
  buffer_load_dwordx4 v[116:119], v4, s[8:11], s57 offen sc1
  s_waitcnt vmcnt(23)
  s_waitcnt vmcnt(36)
  v_mfma_f32_16x16x32_bf16 v[10:13], v[120:123], v[200:203], v[10:13]
  v_mfma_f32_16x16x32_bf16 v[14:17], v[120:123], v[204:207], v[14:17]
  v_mfma_f32_16x16x32_bf16 v[18:21], v[120:123], v[208:211], v[18:21]
  v_mfma_f32_16x16x32_bf16 v[22:25], v[120:123], v[212:215], v[22:25]
  v_mfma_f32_16x16x32_bf16 v[26:29], v[124:127], v[200:203], v[26:29]
  v_mfma_f32_16x16x32_bf16 v[30:33], v[124:127], v[204:207], v[30:33]
  v_mfma_f32_16x16x32_bf16 v[34:37], v[124:127], v[208:211], v[34:37]
  v_mfma_f32_16x16x32_bf16 v[38:41], v[124:127], v[212:215], v[38:41]
  v_mfma_f32_16x16x32_bf16 v[42:45], v[128:131], v[200:203], v[42:45]
  v_mfma_f32_16x16x32_bf16 v[46:49], v[128:131], v[204:207], v[46:49]
  v_mfma_f32_16x16x32_bf16 v[50:53], v[128:131], v[208:211], v[50:53]
  v_mfma_f32_16x16x32_bf16 v[54:57], v[128:131], v[212:215], v[54:57]
  v_mfma_f32_16x16x32_bf16 v[58:61], v[132:135], v[200:203], v[58:61]
  v_mfma_f32_16x16x32_bf16 v[62:65], v[132:135], v[204:207], v[62:65]
  v_mfma_f32_16x16x32_bf16 v[66:69], v[132:135], v[208:211], v[66:69]
  v_mfma_f32_16x16x32_bf16 v[70:73], v[132:135], v[212:215], v[70:73]
  v_mfma_f32_16x16x32_bf16 v[74:77], v[136:139], v[200:203], v[74:77]
  v_mfma_f32_16x16x32_bf16 v[78:81], v[136:139], v[204:207], v[78:81]
  v_mfma_f32_16x16x32_bf16 v[82:85], v[136:139], v[208:211], v[82:85]
  v_mfma_f32_16x16x32_bf16 v[86:89], v[136:139], v[212:215], v[86:89]
  s_add_u32 s56, s44, 36864
  buffer_load_dwordx4 v[200:203], v3, s[24:27], s56 offen offset:0 sc1
  buffer_load_dwordx4 v[204:207], v3, s[24:27], s56 offen offset:1024 sc1
  buffer_load_dwordx4 v[208:211], v3, s[24:27], s56 offen offset:2048 sc1
  buffer_load_dwordx4 v[212:215], v3, s[24:27], s56 offen offset:3072 sc1
  s_add_u32 s57, s45, 56320
  buffer_load_dwordx4 v[120:123], v3, s[8:11], s57 offen offset:0 sc1
  buffer_load_dwordx4 v[124:127], v3, s[8:11], s57 offen offset:1024 sc1
  buffer_load_dwordx4 v[128:131], v3, s[8:11], s57 offen offset:2048 sc1
  buffer_load_dwordx4 v[132:135], v3, s[8:11], s57 offen offset:3072 sc1
  buffer_load_dwordx4 v[136:139], v4, s[8:11], s57 offen sc1
  s_waitcnt vmcnt(23)
  s_waitcnt vmcnt(36)
  v_mfma_f32_16x16x32_bf16 v[10:13], v[140:143], v[216:219], v[10:13]
  v_mfma_f32_16x16x32_bf16 v[14:17], v[140:143], v[220:223], v[14:17]
  v_mfma_f32_16x16x32_bf16 v[18:21], v[140:143], v[224:227], v[18:21]
  v_mfma_f32_16x16x32_bf16 v[22:25], v[140:143], v[228:231], v[22:25]
  v_mfma_f32_16x16x32_bf16 v[26:29], v[144:147], v[216:219], v[26:29]
  v_mfma_f32_16x16x32_bf16 v[30:33], v[144:147], v[220:223], v[30:33]
  v_mfma_f32_16x16x32_bf16 v[34:37], v[144:147], v[224:227], v[34:37]
  v_mfma_f32_16x16x32_bf16 v[38:41], v[144:147], v[228:231], v[38:41]
  v_mfma_f32_16x16x32_bf16 v[42:45], v[148:151], v[216:219], v[42:45]
  v_mfma_f32_16x16x32_bf16 v[46:49], v[148:151], v[220:223], v[46:49]
  v_mfma_f32_16x16x32_bf16 v[50:53], v[148:151], v[224:227], v[50:53]
  v_mfma_f32_16x16x32_bf16 v[54:57], v[148:151], v[228:231], v[54:57]
  v_mfma_f32_16x16x32_bf16 v[58:61], v[152:155], v[216:219], v[58:61]
  v_mfma_f32_16x16x32_bf16 v[62:65], v[152:155], v[220:223], v[62:65]
  v_mfma_f32_16x16x32_bf16 v[66:69], v[152:155], v[224:227], v[66:69]
  v_mfma_f32_16x16x32_bf16 v[70:73], v[152:155], v[228:231], v[70:73]
  v_mfma_f32_16x16x32_bf16 v[74:77], v[156:159], v[216:219], v[74:77]
  v_mfma_f32_16x16x32_bf16 v[78:81], v[156:159], v[220:223], v[78:81]
  v_mfma_f32_16x16x32_bf16 v[82:85], v[156:159], v[224:227], v[82:85]
  v_mfma_f32_16x16x32_bf16 v[86:89], v[156:159], v[228:231], v[86:89]
  s_add_u32 s56, s44, 40960
  buffer_load_dwordx4 v[216:219], v3, s[24:27], s56 offen offset:0 sc1
  buffer_load_dwordx4 v[220:223], v3, s[24:27], s56 offen offset:1024 sc1
  buffer_load_dwordx4 v[224:227], v3, s[24:27], s56 offen offset:2048 sc1
  buffer_load_dwordx4 v[228:231], v3, s[24:27], s56 offen offset:3072 sc1
  s_add_u32 s57, s47, 0
  buffer_load_dwordx4 v[140:143], v3, s[8:11], s57 offen offset:0 sc1
  buffer_load_dwordx4 v[144:147], v3, s[8:11], s57 offen offset:1024 sc1
  buffer_load_dwordx4 v[148:151], v3, s[8:11], s57 offen offset:2048 sc1
  buffer_load_dwordx4 v[152:155], v3, s[8:11], s57 offen offset:3072 sc1
  buffer_load_dwordx4 v[156:159], v4, s[8:11], s57 offen sc1
  buffer_load_dword v9, v7, s[16:19], 0 offen sc1
  s_waitcnt vmcnt(24)
  s_waitcnt vmcnt(37)
  v_mfma_f32_16x16x32_bf16 v[10:13], v[160:163], v[232:235], v[10:13]
  v_mfma_f32_16x16x32_bf16 v[14:17], v[160:163], v[236:239], v[14:17]
  v_mfma_f32_16x16x32_bf16 v[18:21], v[160:163], v[240:243], v[18:21]
  v_mfma_f32_16x16x32_bf16 v[22:25], v[160:163], v[244:247], v[22:25]
  v_mfma_f32_16x16x32_bf16 v[26:29], v[164:167], v[232:235], v[26:29]
  v_mfma_f32_16x16x32_bf16 v[30:33], v[164:167], v[236:239], v[30:33]
  v_mfma_f32_16x16x32_bf16 v[34:37], v[164:167], v[240:243], v[34:37]
  v_mfma_f32_16x16x32_bf16 v[38:41], v[164:167], v[244:247], v[38:41]
  v_mfma_f32_16x16x32_bf16 v[42:45], v[168:171], v[232:235], v[42:45]
  v_mfma_f32_16x16x32_bf16 v[46:49], v[168:171], v[236:239], v[46:49]
  v_mfma_f32_16x16x32_bf16 v[50:53], v[168:171], v[240:243], v[50:53]
  v_mfma_f32_16x16x32_bf16 v[54:57], v[168:171], v[244:247], v[54:57]
  v_mfma_f32_16x16x32_bf16 v[58:61], v[172:175], v[232:235], v[58:61]
  v_mfma_f32_16x16x32_bf16 v[62:65], v[172:175], v[236:239], v[62:65]
  v_mfma_f32_16x16x32_bf16 v[66:69], v[172:175], v[240:243], v[66:69]
  v_mfma_f32_16x16x32_bf16 v[70:73], v[172:175], v[244:247], v[70:73]
  v_mfma_f32_16x16x32_bf16 v[74:77], v[176:179], v[232:235], v[74:77]
  v_mfma_f32_16x16x32_bf16 v[78:81], v[176:179], v[236:239], v[78:81]
  v_mfma_f32_16x16x32_bf16 v[82:85], v[176:179], v[240:243], v[82:85]
  v_mfma_f32_16x16x32_bf16 v[86:89], v[176:179], v[244:247], v[86:89]
  s_add_u32 s56, s44, 45056
  buffer_load_dwordx4 v[232:235], v3, s[24:27], s56 offen offset:0 sc1
  buffer_load_dwordx4 v[236:239], v3, s[24:27], s56 offen offset:1024 sc1
  buffer_load_dwordx4 v[240:243], v3, s[24:27], s56 offen offset:2048 sc1
  buffer_load_dwordx4 v[244:247], v3, s[24:27], s56 offen offset:3072 sc1
  s_add_u32 s57, s47, 5120
  buffer_load_dwordx4 v[160:163], v3, s[8:11], s57 offen offset:0 sc1
  buffer_load_dwordx4 v[164:167], v3, s[8:11], s57 offen offset:1024 sc1
  buffer_load_dwordx4 v[168:171], v3, s[8:11], s57 offen offset:2048 sc1
  buffer_load_dwordx4 v[172:175], v3, s[8:11], s57 offen offset:3072 sc1
  buffer_load_dwordx4 v[176:179], v4, s[8:11], s57 offen sc1
  s_waitcnt vmcnt(9)
  v_cmp_ne_u32 vcc, s82, v9
  s_cbranch_vccz cpd_77
  s_mov_b32 s37, 0
cp_76:
  buffer_load_dword v9, v7, s[16:19], 0 offen sc1
  s_waitcnt vmcnt(0)
  v_cmp_ne_u32 vcc, s82, v9
  s_cbranch_vccz cpd_77
  s_add_u32 s37, s37, 1
  s_cmp_lt_u32 s37, 20000
  s_cbranch_scc0 cpd_77
  s_sleep 4
  s_branch cp_76
cpd_77:
  s_waitcnt vmcnt(24)
  s_waitcnt vmcnt(37)
  v_mfma_f32_16x16x32_bf16 v[10:13], v[180:183], v[200:203], v[10:13]
  v_mfma_f32_16x16x32_bf16 v[14:17], v[180:183], v[204:207], v[14:17]
  v_mfma_f32_16x16x32_bf16 v[18:21], v[180:183], v[208:211], v[18:21]
  v_mfma_f32_16x16x32_bf16 v[22:25], v[180:183], v[212:215], v[22:25]
  v_mfma_f32_16x16x32_bf16 v[26:29], v[184:187], v[200:203], v[26:29]
  v_mfma_f32_16x16x32_bf16 v[30:33], v[184:187], v[204:207], v[30:33]
  v_mfma_f32_16x16x32_bf16 v[34:37], v[184:187], v[208:211], v[34:37]
  v_mfma_f32_16x16x32_bf16 v[38:41], v[184:187], v[212:215], v[38:41]
  v_mfma_f32_16x16x32_bf16 v[42:45], v[188:191], v[200:203], v[42:45]
  v_mfma_f32_16x16x32_bf16 v[46:49], v[188:191], v[204:207], v[46:49]
  v_mfma_f32_16x16x32_bf16 v[50:53], v[188:191], v[208:211], v[50:53]
  v_mfma_f32_16x16x32_bf16 v[54:57], v[188:191], v[212:215], v[54:57]
  v_mfma_f32_16x16x32_bf16 v[58:61], v[192:195], v[200:203], v[58:61]
  v_mfma_f32_16x16x32_bf16 v[62:65], v[192:195], v[204:207], v[62:65]
  v_mfma_f32_16x16x32_bf16 v[66:69], v[192:195], v[208:211], v[66:69]
  v_mfma_f32_16x16x32_bf16 v[70:73], v[192:195], v[212:215], v[70:73]
  v_mfma_f32_16x16x32_bf16 v[74:77], v[196:199], v[200:203], v[74:77]
  v_mfma_f32_16x16x32_bf16 v[78:81], v[196:199], v[204:207], v[78:81]
  v_mfma_f32_16x16x32_bf16 v[82:85], v[196:199], v[208:211], v[82:85]
  v_mfma_f32_16x16x32_bf16 v[86:89], v[196:199], v[212:215], v[86:89]
  s_add_u32 s56, s46, 0
  buffer_load_dwordx4 v[200:203], v3, s[24:27], s56 offen offset:0 sc1
  buffer_load_dwordx4 v[204:207], v3, s[24:27], s56 offen offset:1024 sc1
  buffer_load_dwordx4 v[208:211], v3, s[24:27], s56 offen offset:2048 sc1
  buffer_load_dwordx4 v[212:215], v3, s[24:27], s56 offen offset:3072 sc1
  s_add_u32 s57, s47, 10240
  buffer_load_dwordx4 v[180:183], v3, s[8:11], s57 offen offset:0 sc1
  buffer_load_dwordx4 v[184:187], v3, s[8:11], s57 offen offset:1024 sc1
  buffer_load_dwordx4 v[188:191], v3, s[8:11], s57 offen offset:2048 sc1
  buffer_load_dwordx4 v[192:195], v3, s[8:11], s57 offen offset:3072 sc1
  buffer_load_dwordx4 v[196:199], v4, s[8:11], s57 offen sc1
  s_waitcnt vmcnt(24)
  s_waitcnt vmcnt(37)
  v_mfma_f32_16x16x32_bf16 v[10:13], v[100:103], v[216:219], v[10:13]
  v_mfma_f32_16x16x32_bf16 v[14:17], v[100:103], v[220:223], v[14:17]
  v_mfma_f32_16x16x32_bf16 v[18:21], v[100:103], v[224:227], v[18:21]
  v_mfma_f32_16x16x32_bf16 v[22:25], v[100:103], v[228:231], v[22:25]
  v_mfma_f32_16x16x32_bf16 v[26:29], v[104:107], v[216:219], v[26:29]
  v_mfma_f32_16x16x32_bf16 v[30:33], v[104:107], v[220:223], v[30:33]
  v_mfma_f32_16x16x32_bf16 v[34:37], v[104:107], v[224:227], v[34:37]
  v_mfma_f32_16x16x32_bf16 v[38:41], v[104:107], v[228:231], v[38:41]
  v_mfma_f32_16x16x32_bf16 v[42:45], v[108:111], v[216:219], v[42:45]
  v_mfma_f32_16x16x32_bf16 v[46:49], v[108:111], v[220:223], v[46:49]
  v_mfma_f32_16x16x32_bf16 v[50:53], v[108:111], v[224:227], v[50:53]
  v_mfma_f32_16x16x32_bf16 v[54:57], v[108:111], v[228:231], v[54:57]
  v_mfma_f32_16x16x32_bf16 v[58:61], v[112:115], v[216:219], v[58:61]
  v_mfma_f32_16x16x32_bf16 v[62:65], v[112:115], v[220:223], v[62:65]
  v_mfma_f32_16x16x32_bf16 v[66:69], v[112:115], v[224:227], v[66:69]
  v_mfma_f32_16x16x32_bf16 v[70:73], v[112:115], v[228:231], v[70:73]
  v_mfma_f32_16x16x32_bf16 v[74:77], v[116:119], v[216:219], v[74:77]
  v_mfma_f32_16x16x32_bf16 v[78:81], v[116:119], v[220:223], v[78:81]
  v_mfma_f32_16x16x32_bf16 v[82:85], v[116:119], v[224:227], v[82:85]
  v_mfma_f32_16x16x32_bf16 v[86:89], v[116:119], v[228:231], v[86:89]
  s_add_u32 s56, s46, 4096
  buffer_load_dwordx4 v[216:219], v3, s[24:27], s56 offen offset:0 sc1
  buffer_load_dwordx4 v[220:223], v3, s[24:27], s56 offen offset:1024 sc1
  buffer_load_dwordx4 v[224:227], v3, s[24:27], s56 offen offset:2048 sc1
  buffer_load_dwordx4 v[228:231], v3, s[24:27], s56 offen offset:3072 sc1
  s_add_u32 s57, s47, 15360
  buffer_load_dwordx4 v[100:103], v3, s[8:11], s57 offen offset:0 sc1
  buffer_load_dwordx4 v[104:107], v3, s[8:11], s57 offen offset:1024 sc1
  buffer_load_dwordx4 v[108:111], v3, s[8:11], s57 offen offset:2048 sc1
  buffer_load_dwordx4 v[112:115], v3, s[8:11], s57 offen offset:3072 sc1
  buffer_load_dwordx4 v[116:119], v4, s[8:11], s57 offen sc1
  s_waitcnt vmcnt(23)
  s_waitcnt vmcnt(37)
  v_mfma_f32_16x16x32_bf16 v[10:13], v[120:123], v[232:235], v[10:13]
  v_mfma_f32_16x16x32_bf16 v[14:17], v[120:123], v[236:239], v[14:17]
  v_mfma_f32_16x16x32_bf16 v[18:21], v[120:123], v[240:243], v[18:21]
  v_mfma_f32_16x16x32_bf16 v[22:25], v[120:123], v[244:247], v[22:25]
  v_mfma_f32_16x16x32_bf16 v[26:29], v[124:127], v[232:235], v[26:29]
  v_mfma_f32_16x16x32_bf16 v[30:33], v[124:127], v[236:239], v[30:33]
  v_mfma_f32_16x16x32_bf16 v[34:37], v[124:127], v[240:243], v[34:37]
  v_mfma_f32_16x16x32_bf16 v[38:41], v[124:127], v[244:247], v[38:41]
  v_mfma_f32_16x16x32_bf16 v[42:45], v[128:131], v[232:235], v[42:45]
  v_mfma_f32_16x16x32_bf16 v[46:49], v[128:131], v[236:239], v[46:49]
  v_mfma_f32_16x16x32_bf16 v[50:53], v[128:131], v[240:243], v[50:53]
  v_mfma_f32_16x16x32_bf16 v[54:57], v[128:131], v[244:247], v[54:57]
  v_mfma_f32_16x16x32_bf16 v[58:61], v[132:135], v[232:235], v[58:61]
  v_mfma_f32_16x16x32_bf16 v[62:65], v[132:135], v[236:239], v[62:65]
  v_mfma_f32_16x16x32_bf16 v[66:69], v[132:135], v[240:243], v[66:69]
  v_mfma_f32_16x16x32_bf16 v[70:73], v[132:135], v[244:247], v[70:73]
  v_mfma_f32_16x16x32_bf16 v[74:77], v[136:139], v[232:235], v[74:77]
  v_mfma_f32_16x16x32_bf16 v[78:81], v[136:139], v[236:239], v[78:81]
  v_mfma_f32_16x16x32_bf16 v[82:85], v[136:139], v[240:243], v[82:85]
  v_mfma_f32_16x16x32_bf16 v[86:89], v[136:139], v[244:247], v[86:89]
  s_add_u32 s56, s46, 8192
  buffer_load_dwordx4 v[232:235], v3, s[24:27], s56 offen offset:0 sc1
  buffer_load_dwordx4 v[236:239], v3, s[24:27], s56 offen offset:1024 sc1
  buffer_load_dwordx4 v[240:243], v3, s[24:27], s56 offen offset:2048 sc1
  buffer_load_dwordx4 v[244:247], v3, s[24:27], s56 offen offset:3072 sc1
  s_add_u32 s57, s47, 20480
  buffer_load_dwordx4 v[120:123], v3, s[8:11], s57 offen offset:0 sc1
  buffer_load_dwordx4 v[124:127], v3, s[8:11], s57 offen offset:1024 sc1
  buffer_load_dwordx4 v[128:131], v3, s[8:11], s57 offen offset:2048 sc1
  buffer_load_dwordx4 v[132:135], v3, s[8:11], s57 offen offset:3072 sc1
  buffer_load_dwordx4 v[136:139], v4, s[8:11], s57 offen sc1
  s_waitcnt vmcnt(23)
  s_waitcnt vmcnt(37)
  v_mfma_f32_16x16x32_bf16 v[10:13], v[140:143], v[200:203], v[10:13]
  v_mfma_f32_16x16x32_bf16 v[14:17], v[140:143], v[204:207], v[14:17]
  v_mfma_f32_16x16x32_bf16 v[18:21], v[140:143], v[208:211], v[18:21]
  v_mfma_f32_16x16x32_bf16 v[22:25], v[140:143], v[212:215], v[22:25]
  v_mfma_f32_16x16x32_bf16 v[26:29], v[144:147], v[200:203], v[26:29]
  v_mfma_f32_16x16x32_bf16 v[30:33], v[144:147], v[204:207], v[30:33]
  v_mfma_f32_16x16x32_bf16 v[34:37], v[144:147], v[208:211], v[34:37]
  v_mfma_f32_16x16x32_bf16 v[38:41], v[144:147], v[212:215], v[38:41]
  v_mfma_f32_16x16x32_bf16 v[42:45], v[148:151], v[200:203], v[42:45]
  v_mfma_f32_16x16x32_bf16 v[46:49], v[148:151], v[204:207], v[46:49]
  v_mfma_f32_16x16x32_bf16 v[50:53], v[148:151], v[208:211], v[50:53]
  v_mfma_f32_16x16x32_bf16 v[54:57], v[148:151], v[212:215], v[54:57]
  v_mfma_f32_16x16x32_bf16 v[58:61], v[152:155], v[200:203], v[58:61]
  v_mfma_f32_16x16x32_bf16 v[62:65], v[152:155], v[204:207], v[62:65]
  v_mfma_f32_16x16x32_bf16 v[66:69], v[152:155], v[208:211], v[66:69]
  v_mfma_f32_16x16x32_bf16 v[70:73], v[152:155], v[212:215], v[70:73]
  v_mfma_f32_16x16x32_bf16 v[74:77], v[156:159], v[200:203], v[74:77]
  v_mfma_f32_16x16x32_bf16 v[78:81], v[156:159], v[204:207], v[78:81]
  v_mfma_f32_16x16x32_bf16 v[82:85], v[156:159], v[208:211], v[82:85]
  v_mfma_f32_16x16x32_bf16 v[86:89], v[156:159], v[212:215], v[86:89]
  s_add_u32 s56, s46, 12288
  buffer_load_dwordx4 v[200:203], v3, s[24:27], s56 offen offset:0 sc1
  buffer_load_dwordx4 v[204:207], v3, s[24:27], s56 offen offset:1024 sc1
  buffer_load_dwordx4 v[208:211], v3, s[24:27], s56 offen offset:2048 sc1
  buffer_load_dwordx4 v[212:215], v3, s[24:27], s56 offen offset:3072 sc1
  buffer_load_dwordx2 v[248:249], v6, s[12:15], 0 offen offset:0
  buffer_load_dwordx2 v[250:251], v6, s[12:15], 0 offen offset:32
  buffer_load_dwordx2 v[252:253], v6, s[12:15], 0 offen offset:64
  buffer_load_dwordx2 v[254:255], v6, s[12:15], 0 offen offset:96
  buffer_load_dwordx2 v[8:9], v6, s[12:15], 0 offen offset:128
  s_waitcnt vmcnt(23)
  s_waitcnt vmcnt(36)
  v_mfma_f32_16x16x32_bf16 v[10:13], v[160:163], v[216:219], v[10:13]
  v_mfma_f32_16x16x32_bf16 v[14:17], v[160:163], v[220:223], v[14:17]
  v_mfma_f32_16x16x32_bf16 v[18:21], v[160:163], v[224:227], v[18:21]
  v_mfma_f32_16x16x32_bf16 v[22:25], v[160:163], v[228:231], v[22:25]
  v_mfma_f32_16x16x32_bf16 v[26:29], v[164:167], v[216:219], v[26:29]
  v_mfma_f32_16x16x32_bf16 v[30:33], v[164:167], v[220:223], v[30:33]
  v_mfma_f32_16x16x32_bf16 v[34:37], v[164:167], v[224:227], v[34:37]
  v_mfma_f32_16x16x32_bf16 v[38:41], v[164:167], v[228:231], v[38:41]
  v_mfma_f32_16x16x32_bf16 v[42:45], v[168:171], v[216:219], v[42:45]
  v_mfma_f32_16x16x32_bf16 v[46:49], v[168:171], v[220:223], v[46:49]
  v_mfma_f32_16x16x32_bf16 v[50:53], v[168:171], v[224:227], v[50:53]
  v_mfma_f32_16x16x32_bf16 v[54:57], v[168:171], v[228:231], v[54:57]
  v_mfma_f32_16x16x32_bf16 v[58:61], v[172:175], v[216:219], v[58:61]
  v_mfma_f32_16x16x32_bf16 v[62:65], v[172:175], v[220:223], v[62:65]
  v_mfma_f32_16x16x32_bf16 v[66:69], v[172:175], v[224:227], v[66:69]
  v_mfma_f32_16x16x32_bf16 v[70:73], v[172:175], v[228:231], v[70:73]
  v_mfma_f32_16x16x32_bf16 v[74:77], v[176:179], v[216:219], v[74:77]
  v_mfma_f32_16x16x32_bf16 v[78:81], v[176:179], v[220:223], v[78:81]
  v_mfma_f32_16x16x32_bf16 v[82:85], v[176:179], v[224:227], v[82:85]
  v_mfma_f32_16x16x32_bf16 v[86:89], v[176:179], v[228:231], v[86:89]
  s_add_u32 s56, s46, 16384
  buffer_load_dwordx4 v[216:219], v3, s[24:27], s56 offen offset:0 sc1
  buffer_load_dwordx4 v[220:223], v3, s[24:27], s56 offen offset:1024 sc1
  buffer_load_dwordx4 v[224:227], v3, s[24:27], s56 offen offset:2048 sc1
  buffer_load_dwordx4 v[228:231], v3, s[24:27], s56 offen offset:3072 sc1
  s_waitcnt vmcnt(18)
  s_waitcnt vmcnt(31)
  v_mfma_f32_16x16x32_bf16 v[10:13], v[180:183], v[232:235], v[10:13]
  v_mfma_f32_16x16x32_bf16 v[14:17], v[180:183], v[236:239], v[14:17]
  v_mfma_f32_16x16x32_bf16 v[18:21], v[180:183], v[240:243], v[18:21]
  v_mfma_f32_16x16x32_bf16 v[22:25], v[180:183], v[244:247], v[22:25]
  v_mfma_f32_16x16x32_bf16 v[26:29], v[184:187], v[232:235], v[26:29]
  v_mfma_f32_16x16x32_bf16 v[30:33], v[184:187], v[236:239], v[30:33]
  v_mfma_f32_16x16x32_bf16 v[34:37], v[184:187], v[240:243], v[34:37]
  v_mfma_f32_16x16x32_bf16 v[38:41], v[184:187], v[244:247], v[38:41]
  v_mfma_f32_16x16x32_bf16 v[42:45], v[188:191], v[232:235], v[42:45]
  v_mfma_f32_16x16x32_bf16 v[46:49], v[188:191], v[236:239], v[46:49]
  v_mfma_f32_16x16x32_bf16 v[50:53], v[188:191], v[240:243], v[50:53]
  v_mfma_f32_16x16x32_bf16 v[54:57], v[188:191], v[244:247], v[54:57]
  v_mfma_f32_16x16x32_bf16 v[58:61], v[192:195], v[232:235], v[58:61]
  v_mfma_f32_16x16x32_bf16 v[62:65], v[192:195], v[236:239], v[62:65]
  v_mfma_f32_16x16x32_bf16 v[66:69], v[192:195], v[240:243], v[66:69]
  v_mfma_f32_16x16x32_bf16 v[70:73], v[192:195], v[244:247], v[70:73]
  v_mfma_f32_16x16x32_bf16 v[74:77], v[196:199], v[232:235], v[74:77]
  v_mfma_f32_16x16x32_bf16 v[78:81], v[196:199], v[236:239], v[78:81]
  v_mfma_f32_16x16x32_bf16 v[82:85], v[196:199], v[240:243], v[82:85]
  v_mfma_f32_16x16x32_bf16 v[86:89], v[196:199], v[244:247], v[86:89]
  s_waitcnt vmcnt(9)
  s_waitcnt vmcnt(22)
  v_mfma_f32_16x16x32_bf16 v[10:13], v[100:103], v[200:203], v[10:13]
  v_mfma_f32_16x16x32_bf16 v[14:17], v[100:103], v[204:207], v[14:17]
  v_mfma_f32_16x16x32_bf16 v[18:21], v[100:103], v[208:211], v[18:21]
  v_mfma_f32_16x16x32_bf16 v[22:25], v[100:103], v[212:215], v[22:25]
  v_mfma_f32_16x16x32_bf16 v[26:29], v[104:107], v[200:203], v[26:29]
  v_mfma_f32_16x16x32_bf16 v[30:33], v[104:107], v[204:207], v[30:33]
  v_mfma_f32_16x16x32_bf16 v[34:37], v[104:107], v[208:211], v[34:37]
  v_mfma_f32_16x16x32_bf16 v[38:41], v[104:107], v[212:215], v[38:41]
  v_mfma_f32_16x16x32_bf16 v[42:45], v[108:111], v[200:203], v[42:45]
  v_mfma_f32_16x16x32_bf16 v[46:49], v[108:111], v[204:207], v[46:49]
  v_mfma_f32_16x16x32_bf16 v[50:53], v[108:111], v[208:211], v[50:53]
  v_mfma_f32_16x16x32_bf16 v[54:57], v[108:111], v[212:215], v[54:57]
  v_mfma_f32_16x16x32_bf16 v[58:61], v[112:115], v[200:203], v[58:61]
  v_mfma_f32_16x16x32_bf16 v[62:65], v[112:115], v[204:207], v[62:65]
  v_mfma_f32_16x16x32_bf16 v[66:69], v[112:115], v[208:211], v[66:69]
  v_mfma_f32_16x16x32_bf16 v[70:73], v[112:115], v[212:215], v[70:73]
  v_mfma_f32_16x16x32_bf16 v[74:77], v[116:119], v[200:203], v[74:77]
  v_mfma_f32_16x16x32_bf16 v[78:81], v[116:119], v[204:207], v[78:81]
  v_mfma_f32_16x16x32_bf16 v[82:85], v[116:119], v[208:211], v[82:85]
  v_mfma_f32_16x16x32_bf16 v[86:89], v[116:119], v[212:215], v[86:89]
  s_waitcnt vmcnt(0)
  s_waitcnt vmcnt(13)
  v_mfma_f32_16x16x32_bf16 v[10:13], v[120:123], v[216:219], v[10:13]
  v_mfma_f32_16x16x32_bf16 v[14:17], v[120:123], v[220:223], v[14:17]
  v_mfma_f32_16x16x32_bf16 v[18:21], v[120:123], v[224:227], v[18:21]
  v_mfma_f32_16x16x32_bf16 v[22:25], v[120:123], v[228:231], v[22:25]
  v_mfma_f32_16x16x32_bf16 v[26:29], v[124:127], v[216:219], v[26:29]
  v_mfma_f32_16x16x32_bf16 v[30:33], v[124:127], v[220:223], v[30:33]
  v_mfma_f32_16x16x32_bf16 v[34:37], v[124:127], v[224:227], v[34:37]
  v_mfma_f32_16x16x32_bf16 v[38:41], v[124:127], v[228:231], v[38:41]
  v_mfma_f32_16x16x32_bf16 v[42:45], v[128:131], v[216:219], v[42:45]
  v_mfma_f32_16x16x32_bf16 v[46:49], v[128:131], v[220:223], v[46:49]
  v_mfma_f32_16x16x32_bf16 v[50:53], v[128:131], v[224:227], v[50:53]
  v_mfma_f32_16x16x32_bf16 v[54:57], v[128:131], v[228:231], v[54:57]
  v_mfma_f32_16x16x32_bf16 v[58:61], v[132:135], v[216:219], v[58:61]
  v_mfma_f32_16x16x32_bf16 v[62:65], v[132:135], v[220:223], v[62:65]
  v_mfma_f32_16x16x32_bf16 v[66:69], v[132:135], v[224:227], v[66:69]
  v_mfma_f32_16x16x32_bf16 v[70:73], v[132:135], v[228:231], v[70:73]
  v_mfma_f32_16x16x32_bf16 v[74:77], v[136:139], v[216:219], v[74:77]
  v_mfma_f32_16x16x32_bf16 v[78:81], v[136:139], v[220:223], v[78:81]
  v_mfma_f32_16x16x32_bf16 v[82:85], v[136:139], v[224:227], v[82:85]
  v_mfma_f32_16x16x32_bf16 v[86:89], v[136:139], v[228:231], v[86:89]
  s_nop 15
  s_mul_i32 s39, s35, 20480
  s_add_u32 s39, s39, 69632
  v_add_u32 v7, s39, v3
  ds_write_b128 v7, v[10:13] offset:0
  ds_write_b128 v7, v[14:17] offset:1024
  ds_write_b128 v7, v[18:21] offset:2048
  ds_write_b128 v7, v[22:25] offset:3072
  ds_write_b128 v7, v[26:29] offset:4096
  ds_write_b128 v7, v[30:33] offset:5120
  ds_write_b128 v7, v[34:37] offset:6144
  ds_write_b128 v7, v[38:41] offset:7168
  ds_write_b128 v7, v[42:45] offset:8192
  ds_write_b128 v7, v[46:49] offset:9216
  ds_write_b128 v7, v[50:53] offset:10240
  ds_write_b128 v7, v[54:57] offset:11264
  ds_write_b128 v7, v[58:61] offset:12288
  ds_write_b128 v7, v[62:65] offset:13312
  ds_write_b128 v7, v[66:69] offset:14336
  ds_write_b128 v7, v[70:73] offset:15360
  ds_write_b128 v7, v[74:77] offset:16384
  ds_write_b128 v7, v[78:81] offset:17408
  ds_write_b128 v7, v[82:85] offset:18432
  ds_write_b128 v7, v[86:89] offset:19456
  s_waitcnt lgkmcnt(0)
  s_barrier
  s_lshl_b32 s39, s35, 10
  s_add_u32 s39, s39, 69632
  v_add_u32 v7, s39, v3
  v_add_u32 v2, 40960, v7
  ds_read_b128 v[100:103], v7 offset:0
  ds_read_b128 v[104:107], v7 offset:20480
  ds_read_b128 v[108:111], v2 offset:0
  ds_read_b128 v[112:115], v2 offset:20480
  ds_read_b128 v[116:119], v7 offset:4096
  ds_read_b128 v[120:123], v7 offset:24576
  ds_read_b128 v[124:127], v2 offset:4096
  ds_read_b128 v[128:131], v2 offset:24576
  ds_read_b128 v[132:135], v7 offset:8192
  ds_read_b128 v[136:139], v7 offset:28672
  ds_read_b128 v[140:143], v2 offset:8192
  ds_read_b128 v[144:147], v2 offset:28672
  ds_read_b128 v[148:151], v7 offset:12288
  ds_read_b128 v[152:155], v7 offset:32768
  ds_read_b128 v[156:159], v2 offset:12288
  ds_read_b128 v[160:163], v2 offset:32768
  ds_read_b128 v[164:167], v7 offset:16384
  ds_read_b128 v[168:171], v7 offset:36864
  ds_read_b128 v[172:175], v2 offset:16384
  ds_read_b128 v[176:179], v2 offset:36864
  s_waitcnt vmcnt(4)
  s_waitcnt lgkmcnt(0)
  v_add_f32 v100, v100, v104
  v_add_f32 v108, v108, v112
  v_add_f32 v101, v101, v105
  v_add_f32 v109, v109, v113
  v_add_f32 v102, v102, v106
  v_add_f32 v110, v110, v114
  v_add_f32 v103, v103, v107
  v_add_f32 v111, v111, v115
  v_add_f32 v100, v100, v108
  v_add_f32 v101, v101, v109
  v_add_f32 v102, v102, v110
  v_add_f32 v103, v103, v111
  v_lshlrev_b32 v10, 16, v90
  v_and_b32 v11, 0xffff0000, v90
  v_lshlrev_b32 v12, 16, v91
  v_and_b32 v13, 0xffff0000, v91
  v_lshlrev_b32 v14, 16, v248
  v_and_b32 v15, 0xffff0000, v248
  v_lshlrev_b32 v16, 16, v249
  v_and_b32 v17, 0xffff0000, v249
  v_add_f32 v100, v100, v14
  v_add_f32 v101, v101, v15
  v_add_f32 v102, v102, v16
  v_add_f32 v103, v103, v17
  v_add_f32 v100, v100, v10
  v_add_f32 v101, v101, v11
  v_add_f32 v102, v102, v12
  v_add_f32 v103, v103, v13
  v_cvt_pk_bf16_f32 v20, v100, v101
  v_cvt_pk_bf16_f32 v21, v102, v103
  buffer_store_dwordx2 v[20:21], v5, s[20:23], 0 offen offset:0 sc1
  v_add_f32 v116, v116, v120
  v_add_f32 v124, v124, v128
  v_add_f32 v117, v117, v121
  v_add_f32 v125, v125, v129
  v_add_f32 v118, v118, v122
  v_add_f32 v126, v126, v130
  v_add_f32 v119, v119, v123
  v_add_f32 v127, v127, v131
  v_add_f32 v116, v116, v124
  v_add_f32 v117, v117, v125
  v_add_f32 v118, v118, v126
  v_add_f32 v119, v119, v127
  v_lshlrev_b32 v10, 16, v92
  v_and_b32 v11, 0xffff0000, v92
  v_lshlrev_b32 v12, 16, v93
  v_and_b32 v13, 0xffff0000, v93
  v_lshlrev_b32 v14, 16, v250
  v_and_b32 v15, 0xffff0000, v250
  v_lshlrev_b32 v16, 16, v251
  v_and_b32 v17, 0xffff0000, v251
  v_add_f32 v116, v116, v14
  v_add_f32 v117, v117, v15
  v_add_f32 v118, v118, v16
  v_add_f32 v119, v119, v17
  v_add_f32 v116, v116, v10
  v_add_f32 v117, v117, v11
  v_add_f32 v118, v118, v12
  v_add_f32 v119, v119, v13
  v_cvt_pk_bf16_f32 v22, v116, v117
  v_cvt_pk_bf16_f32 v23, v118, v119
  buffer_store_dwordx2 v[22:23], v5, s[20:23], 0 offen offset:32 sc1
  v_add_f32 v132, v132, v136
  v_add_f32 v140, v140, v144
  v_add_f32 v133, v133, v137
  v_add_f32 v141, v141, v145
  v_add_f32 v134, v134, v138
  v_add_f32 v142, v142, v146
  v_add_f32 v135, v135, v139
  v_add_f32 v143, v143, v147
  v_add_f32 v132, v132, v140
  v_add_f32 v133, v133, v141
  v_add_f32 v134, v134, v142
  v_add_f32 v135, v135, v143
  v_lshlrev_b32 v10, 16, v94
  v_and_b32 v11, 0xffff0000, v94
  v_lshlrev_b32 v12, 16, v95
  v_and_b32 v13, 0xffff0000, v95
  v_lshlrev_b32 v14, 16, v252
  v_and_b32 v15, 0xffff0000, v252
  v_lshlrev_b32 v16, 16, v253
  v_and_b32 v17, 0xffff0000, v253
  v_add_f32 v132, v132, v14
  v_add_f32 v133, v133, v15
  v_add_f32 v134, v134, v16
  v_add_f32 v135, v135, v17
  v_add_f32 v132, v132, v10
  v_add_f32 v133, v133, v11
  v_add_f32 v134, v134, v12
  v_add_f32 v135, v135, v13
  v_cvt_pk_bf16_f32 v24, v132, v133
  v_cvt_pk_bf16_f32 v25, v134, v135
  buffer_store_dwordx2 v[24:25], v5, s[20:23], 0 offen offset:64 sc1
  v_add_f32 v148, v148, v152
  v_add_f32 v156, v156, v160
  v_add_f32 v149, v149, v153
  v_add_f32 v157, v157, v161
  v_add_f32 v150, v150, v154
  v_add_f32 v158, v158, v162
  v_add_f32 v151, v151, v155
  v_add_f32 v159, v159, v163
  v_add_f32 v148, v148, v156
  v_add_f32 v149, v149, v157
  v_add_f32 v150, v150, v158
  v_add_f32 v151, v151, v159
  v_lshlrev_b32 v10, 16, v96
  v_and_b32 v11, 0xffff0000, v96
  v_lshlrev_b32 v12, 16, v97
  v_and_b32 v13, 0xffff0000, v97
  v_lshlrev_b32 v14, 16, v254
  v_and_b32 v15, 0xffff0000, v254
  v_lshlrev_b32 v16, 16, v255
  v_and_b32 v17, 0xffff0000, v255
  v_add_f32 v148, v148, v14
  v_add_f32 v149, v149, v15
  v_add_f32 v150, v150, v16
  v_add_f32 v151, v151, v17
  v_add_f32 v148, v148, v10
  v_add_f32 v149, v149, v11
  v_add_f32 v150, v150, v12
  v_add_f32 v151, v151, v13
  v_cvt_pk_bf16_f32 v26, v148, v149
  v_cvt_pk_bf16_f32 v27, v150, v151
  buffer_store_dwordx2 v[26:27], v5, s[20:23], 0 offen offset:96 sc1
  v_add_f32 v164, v164, v168
  v_add_f32 v172, v172, v176
  v_add_f32 v165, v165, v169
  v_add_f32 v173, v173, v177
  v_add_f32 v166, v166, v170
  v_add_f32 v174, v174, v178
  v_add_f32 v167, v167, v171
  v_add_f32 v175, v175, v179
  v_add_f32 v164, v164, v172
  v_add_f32 v165, v165, v173
  v_add_f32 v166, v166, v174
  v_add_f32 v167, v167, v175
  v_lshlrev_b32 v10, 16, v98
  v_and_b32 v11, 0xffff0000, v98
  v_lshlrev_b32 v12, 16, v99
  v_and_b32 v13, 0xffff0000, v99
  v_lshlrev_b32 v14, 16, v8
  v_and_b32 v15, 0xffff0000, v8
  v_lshlrev_b32 v16, 16, v9
  v_and_b32 v17, 0xffff0000, v9
  v_add_f32 v164, v164, v14
  v_add_f32 v165, v165, v15
  v_add_f32 v166, v166, v16
  v_add_f32 v167, v167, v17
  v_add_f32 v164, v164, v10
  v_add_f32 v165, v165, v11
  v_add_f32 v166, v166, v12
  v_add_f32 v167, v167, v13
  v_cvt_pk_bf16_f32 v28, v164, v165
  v_cvt_pk_bf16_f32 v29, v166, v167
  buffer_store_dwordx2 v[28:29], v5, s[20:23], 0 offen offset:128 sc1
L_end:
  s_endpgm
L_codeend:
.section .rodata,"a"
.p2align 6
.amdhsa_kernel parallel_sum__sliding_block__mixer_channel_mlp__prompt_kernel
  .amdhsa_next_free_vgpr 256
  .amdhsa_next_free_sgpr 102
  .amdhsa_accum_offset 256
  .amdhsa_group_segment_fixed_size 0
  .amdhsa_kernarg_size 88
  .amdhsa_user_sgpr_count 2
  .amdhsa_user_sgpr_kernarg_segment_ptr 1
  .amdhsa_system_sgpr_workgroup_id_x 1
.end_amdhsa_kernel
```
